```python
import torch

def _softmax(x, axis=-1):
    return torch.softmax(x, dim=axis)
def _gelu(x):
    return torch.nn.functional.gelu(x, approximate="tanh")
def _silu(x):
    return torch.nn.functional.silu(x)
def _sigmoid(x):
    return torch.sigmoid(x)
def _layernorm(x, axis=-1, eps=1e-5):
    m = x.mean(dim=axis, keepdim=True)
    v = x.var(dim=axis, keepdim=True, unbiased=False)
    return (x - m) / torch.sqrt(v + eps)
def _scatter_add(tgt, idx, src, axis=0):
    return tgt.clone().index_add_(axis, idx, src)
def _segment_sum(src, seg, n):
    out = torch.zeros((n,) + src.shape[1:], dtype=src.dtype)
    return out.index_add_(0, seg, src)
def _pad(x, pw):
    flat = tuple(v for pair in reversed(pw) for v in pair)
    return torch.nn.functional.pad(x, flat)

kernel_name = 'sequential_preLN__sliding_local_dilated__dense_activation_gelu__prompt'

def setup_inputs():

    _w = (lambda a: (lambda t: t.to(torch.bfloat16) if t.is_floating_point() else t)(torch.as_tensor(a)))
    def _A_setup():
        B, S, D = 1, 2048, 448
        return {
            "x": _w((lambda *s: torch.randn(*s, dtype=torch.bfloat16) * 0.05)(B, S, D)),
            "wqkv": _w((lambda *s: torch.randn(*s, dtype=torch.bfloat16) * 0.05)(D, 3 * D)),
            "wo": _w((lambda *s: torch.randn(*s, dtype=torch.bfloat16) * 0.05)(D, D)),
        }
    _A_in = _A_setup()

    def _B_setup():
        B, S, D, F = 1, 2048, 448, 1792
        return {
            "x": _w((lambda *s: torch.randn(*s, dtype=torch.bfloat16) * 0.05)(B, S, D)),
            "w1": _w((lambda *s: torch.randn(*s, dtype=torch.bfloat16) * 0.8)(D, F) * (D ** -0.5)),
            "b1": _w((lambda *s: torch.randn(*s, dtype=torch.bfloat16) * 0.8)(F) * 0.01),
            "w2": _w((lambda *s: torch.randn(*s, dtype=torch.bfloat16) * 0.8)(F, D) * (F ** -0.5)),
            "b2": _w((lambda *s: torch.randn(*s, dtype=torch.bfloat16) * 0.8)(D) * 0.01),
        }
    _B_in = _B_setup()

    return {
        "A_x": _A_in["x"],
        "A_wqkv": _A_in["wqkv"],
        "A_wo": _A_in["wo"],
        "B_x": _B_in["x"],
        "B_w1": _B_in["w1"],
        "B_b1": _B_in["b1"],
        "B_w2": _B_in["w2"],
        "B_b2": _B_in["b2"],
    }

def reference(A_x, A_wqkv, A_wo, B_x, B_w1, B_b1, B_w2, B_b2):
    def _A_ref(x, wqkv, wo):
        B, S, D = x.shape
        H = 16; Dh = D // H
        W, dil = 8, 2
        qkv = (lambda x, *d: x.permute(*d))((x @ wqkv).reshape(B, S, 3, H, Dh), 2, 0, 3, 1, 4)
        q, k, v = qkv[0], qkv[1], qkv[2]
        scale = Dh ** -0.5
        pos = torch.arange(S)
        off = torch.arange(W) * dil
        idx = pos[:, None] - off[None, :]
        mask = idx >= 0
        idx_c = torch.where(mask, idx, 0).reshape(-1)
        kg = k[:, :, idx_c, :].reshape(B, H, S, W, Dh)
        vg = v[:, :, idx_c, :].reshape(B, H, S, W, Dh)
        logits = torch.einsum("bhsd,bhswd->bhsw", q, kg) * scale
        logits = torch.where(mask[None, None, :, :], logits, -1e9)
        attn = _softmax(logits, axis=-1)
        o = torch.einsum("bhsw,bhswd->bhsd", attn, vg)
        return (lambda x, *d: x.permute(*d))(o, 0, 2, 1, 3).reshape(B, S, D) @ wo

    def _B_ref(x, w1, b1, w2, b2):
        h = torch.einsum("bsd,df->bsf", x, w1) + b1
        h = _gelu(h)
        return torch.einsum("bsf,fd->bsd", h, w2) + b2

    x = A_x
    h = x + _A_ref(_layernorm(x, axis=-1), A_wqkv, A_wo)
    h2 = h + _B_ref(_layernorm(h, axis=-1), B_w1, B_b1, B_w2, B_b2)
    return h2
```

```asm
; @launch grid=(256,1,1) block=(512,1,1) lds=163840
.amdgcn_target "amdgcn-amd-amdhsa--gfx950"
.text
.globl sequential_preLN__sliding_local_dilated__dense_activation_gelu__prompt_kernel
.p2align 12
.p2align 8
.type sequential_preLN__sliding_local_dilated__dense_activation_gelu__prompt_kernel,@function
sequential_preLN__sliding_local_dilated__dense_activation_gelu__prompt_kernel:
    s_load_dwordx16 s[8:23], s[0:1], 0
    s_load_dwordx2 s[24:25], s[0:1], 64
    s_load_dwordx2 s[28:29], s[0:1], 80
    s_cmp_ge_u32 s2, 256
    s_cbranch_scc1 Lend
    v_lshrrev_b32 v1, 6, v0
    s_lshr_b32 s5, s2, 3
    s_and_b32 s70, s5, 15
    v_readfirstlane_b32 s7, v1
    v_and_b32 v0, 63, v0
    s_and_b32 s4, s2, 7
    s_lshr_b32 s5, s5, 3
    s_lshl_b32 s64, s4, 2
    s_add_u32 s64, s64, s5
    s_and_b32 s62, s70, 7
    s_lshl_b32 s5, s5, 1
    s_add_u32 s5, s5, s62
    s_add_u32 s5, s5, s4
    s_mul_i32 s6, s5, 37
    s_lshr_b32 s6, s6, 8
    s_mul_i32 s6, s6, 7
    s_sub_u32 s65, s5, s6
    s_and_b32 s60, s7, 3
    s_and_b32 s66, s60, 1
    s_lshr_b32 s67, s60, 1
    s_cmp_ge_u32 s7, 4
    s_cbranch_scc1 LA0
    s_cmp_eq_u32 s62, 7
    s_cbranch_scc1 LS
    s_lshl_b32 s72, s65, 7
    v_lshrrev_b32 v5, 3, v0
    v_and_b32 v6, 6, v5
    v_xor_b32 v8, v6, v0
    v_and_b32 v8, 7, v8
    v_and_b32 v6, 4, v5
    v_add_u32 v6, v6, v5
    s_lshl_b32 s4, s66, 2
    s_lshl_b32 s5, s67, 4
    s_add_u32 s4, s4, s5
    v_add_u32 v6, s4, v6
    s_lshl_b32 s4, s62, 7
    v_lshl_add_u32 v7, v8, 4, s4
    s_movk_i32 s6, 2688
    v_mad_u32_u24 v4, v6, s6, v7
    s_lshl_b32 s80, s60, 10
    s_mov_b32 s38, 1204224
    s_mov_b32 s39, 0x20000
    s_waitcnt lgkmcnt(0)
    s_load_dword s100, s[8:9], 0
    s_mov_b64 s[32:33], s[8:9]
    s_mov_b64 s[36:37], s[10:11]
    s_add_u32 m0, s80, 81920
    s_mul_i32 s3, s72, 1344
    buffer_load_dwordx4 v4, s[36:39], s3 offen  lds
    s_add_u32 m0, s80, 85120
    s_nop 0
    buffer_load_dwordx4 v4, s[36:39], s3 offen offset:896  lds
    s_add_u32 m0, s80, 90112
    s_add_u32 s3, s3, 86016
    buffer_load_dwordx4 v4, s[36:39], s3 offen  lds
    s_add_u32 m0, s80, 93312
    s_nop 0
    buffer_load_dwordx4 v4, s[36:39], s3 offen offset:896  lds
    v_lshrrev_b32 v5, 3, v0
    v_lshrrev_b32 v6, 4, v0
    v_xor_b32 v6, v6, v0
    v_and_b32 v6, 7, v6
    v_lshlrev_b32 v6, 4, v6
    s_lshl_b32 s4, s64, 6
    s_lshl_b32 s5, s60, 4
    s_add_u32 s5, s5, s4
    s_sub_u32 s4, s4, 16
    s_max_i32 s4, s4, 0
    s_movk_i32 s6, 896
    v_add_u32 v2, s5, v5
    v_mad_u32_u24 v2, v2, s6, v6
    v_add_u32 v3, s4, v5
    v_mad_u32_u24 v3, v3, s6, v6
    v_xor_b32 v11, 64, v2
    v_xor_b32 v12, 64, v3
    v_add_u32 v11, 7168, v11
    v_add_u32 v12, 7168, v12
    s_lshl_b32 s79, s60, 11
    s_mov_b32 s34, 1835008
    s_mov_b32 s35, 0x20000
    s_add_u32 m0, s79, 2048
    s_nop 0
    buffer_load_dwordx4 v2, s[32:35], s72 offen  lds
    s_add_u32 m0, s79, 3072
    s_nop 0
    buffer_load_dwordx4 v11, s[32:35], s72 offen  lds
    s_mov_b32 s4, s60
    s_add_u32 s5, s4, s65
    s_cmp_ge_u32 s5, 7
    s_cselect_b32 s6, 7, 0
    s_sub_u32 s5, s5, s6
    s_lshl_b32 s5, s5, 7
    s_mul_i32 s4, s4, 10240
    s_mov_b32 exec_lo, 0xffffff00
    s_add_u32 m0, s4, 0
    s_nop 0
    buffer_load_dwordx4 v3, s[32:35], s5 offen  lds
    s_mov_b64 exec, -1
    s_add_u32 m0, s4, 1024
    s_nop 0
    buffer_load_dwordx4 v12, s[32:35], s5 offen  lds
    s_add_u32 s4, s60, 4
    s_min_u32 s4, s4, 6
    s_add_u32 s5, s4, s65
    s_cmp_ge_u32 s5, 7
    s_cselect_b32 s6, 7, 0
    s_sub_u32 s5, s5, s6
    s_lshl_b32 s5, s5, 7
    s_mul_i32 s4, s4, 10240
    s_mov_b32 exec_lo, 0xffffff00
    s_add_u32 m0, s4, 0
    s_nop 0
    buffer_load_dwordx4 v3, s[32:35], s5 offen  lds
    s_mov_b64 exec, -1
    s_add_u32 m0, s4, 1024
    s_nop 0
    buffer_load_dwordx4 v12, s[32:35], s5 offen  lds
    s_branch LB1
LA0:
    s_getpc_b64 s[26:27]
Lpc:
    s_sub_u32 s26, s26, Lpc-sequential_preLN__sliding_local_dilated__dense_activation_gelu__prompt_kernel
    s_subb_u32 s27, s27, 0
    v_mad_u32_u24 v5, s60, 5, v0
    v_lshlrev_b32 v5, 7, v5
    s_mul_i32 s4, s70, 2560
    v_add_u32 v5, s4, v5
    v_min_u32 v5, Lend-sequential_preLN__sliding_local_dilated__dense_activation_gelu__prompt_kernel, v5
    s_mov_b64 exec, 31
    global_load_dword a127, v5, s[26:27]
    s_mov_b64 exec, -1
    s_lshr_b32 s63, s64, 1
    s_mul_i32 s4, s63, 2097152
    s_waitcnt lgkmcnt(0)
    s_add_u32 s56, s28, s4
    s_addc_u32 s57, s29, 0
    s_load_dword s28, s[56:57], 724736
    s_cmp_lg_u32 s62, 7
    s_cbranch_scc1 LA
    s_endpgm
LA:
    s_setprio 1
    s_and_b32 s61, s64, 1
    s_mul_i32 s71, s61, 7
    s_add_u32 s71, s71, s62
    v_and_b32 v9, 15, v0
    v_lshrrev_b32 v10, 4, v0
    v_lshlrev_b32 v14, 4, v0
    s_mov_b32 s58, 0x200000
    s_mov_b32 s59, 0x20000
    s_mov_b64 s[52:53], s[24:25]
    s_mov_b32 s54, 1835008
    s_mov_b32 s55, 0x20000
    v_mov_b32 v16, 0x3f803f80
    v_mov_b32 v17, 0x3f803f80
    v_mov_b32 v18, 0x3f803f80
    v_mov_b32 v19, 0x3f803f80
    v_lshrrev_b32 v5, 3, v0
    v_min_u32 v5, 6, v5
    v_mul_u32_u24 v5, 10240, v5
    v_and_b32 v6, 7, v0
    v_lshl_add_u32 v5, v6, 4, v5
    ds_write_b128 v5, v[16:19]
    v_lshrrev_b32 v96, 1, v9
    v_xor_b32 v96, v96, v10
    v_lshlrev_b32 v96, 4, v96
    v_lshl_add_u32 v96, v9, 7, v96
    v_xor_b32 v97, 64, v96
    s_lshl_b32 s4, s67, 12
    v_add_u32 v2, s4, v96
    v_cmp_eq_u32 vcc, 0, v9
    s_nop 1
    v_cndmask_b32 v4, v2, v96, vcc
    v_xor_b32 v3, 64, v2
    v_xor_b32 v8, 64, v4
    s_sub_i32 s4, s62, s65
    s_cmp_lt_i32 s4, 0
    s_cselect_b32 s5, 7, 0
    s_add_u32 s4, s4, s5
    s_mul_i32 s4, s4, 5
    s_add_u32 s4, s4, s60
    s_add_u32 s4, s4, 1
    s_lshl_b32 s4, s4, 11
    v_xor_b32 v5, v10, v9
    v_lshrrev_b32 v5, 1, v5
    v_lshlrev_b32 v5, 4, v5
    v_lshl_add_u32 v5, v9, 7, v5
    v_and_b32 v6, 1, v10
    v_lshl_add_u32 v5, v6, 3, v5
    v_add_u32 v104, s4, v5
    v_xor_b32 v105, 32, v104
    v_xor_b32 v106, 64, v104
    v_xor_b32 v107, 96, v104
    v_lshrrev_b32 v122, 2, v9
    v_and_b32 v123, 3, v0
    v_and_b32 v5, 2, v10
    v_lshlrev_b32 v5, 3, v5
    v_lshl_add_u32 v5, v6, 2, v5
    v_add_u32 v7, v5, v122
    v_and_b32 v6, 6, v7
    v_lshlrev_b32 v6, 4, v6
    v_lshl_add_u32 v6, v123, 3, v6
    v_lshl_add_u32 v6, v7, 7, v6
    s_lshl_b32 s4, s60, 5
    v_xor_b32 v5, s4, v6
    v_add_u32 v98, 73728, v5
    v_add_u32 v99, 131072, v5
    s_lshl_b32 s4, s66, 6
    v_xor_b32 v5, s4, v6
    v_add_u32 v118, 73728, v5
    v_add_u32 v120, 131072, v5
    v_xor_b32 v119, 32, v118
    v_xor_b32 v121, 32, v120
    v_lshlrev_b32 v5, 2, v10
    v_sub_u32 v6, v9, v5
    v_and_b32 v7, 1, v0
    v_cmp_eq_u32 s[90:91], 1, v7
    v_cmp_le_i32 s[92:93], v7, v6
    v_add_u32 v7, 2, v7
    v_cmp_le_i32 s[94:95], v7, v6
    s_or_b32 s4, s64, s67
    s_cmp_eq_u32 s4, 0
    s_cselect_b64 s[96:97], s[92:93], -1
    s_cselect_b64 s[98:99], s[94:95], -1
    v_mov_b32 v5, 0xffff
    v_mov_b32 v6, 0xffff0000
    v_cndmask_b32 v13, v5, v6, s[90:91]
    v_and_b32 v5, 31, v0
    s_lshl_b32 s4, s71, 8
    s_lshl_b32 s5, s60, 6
    s_add_u32 s4, s4, s5
    v_lshl_add_u32 v5, v5, 1, s4
    global_load_ushort a112, v5, s[18:19]
    s_lshl_b32 s4, s62, 7
    v_lshl_add_u32 v6, v9, 3, s4
    global_load_dwordx2 a[114:115], v6, s[22:23]
    s_waitcnt lgkmcnt(0)
    s_add_u32 s26, s28, 1
    s_mov_b32 s27, s26
    v_mov_b32 v15, s26
    s_getreg_b32 s4, hwreg(HW_REG_XCC_ID, 0, 4)
    s_lshl_b32 s69, s26, 4
    s_or_b32 s69, s69, s4
    s_cmp_lg_u32 s60, 0
    s_cbranch_scc1 Lni
    v_mov_b32 v1, s69
    s_lshl_b32 s4, s71, 2
    s_add_u32 s4, s4, 720896
    s_mov_b64 exec, 1
    buffer_store_dword v1, v0, s[56:59], s4 offen sc1
    s_mov_b64 exec, -1
Lni:
    s_cmp_lg_u32 s60, 0
    s_cbranch_scc1 Ltc0
    s_call_b64 s[28:29], Lstub0
    s_call_b64 s[28:29], Lstub4
Ltc0:
    s_cmp_lg_u32 s60, 1
    s_cbranch_scc1 Ltc1
    s_call_b64 s[28:29], Lstub1
    s_call_b64 s[28:29], Lstub5
Ltc1:
    s_cmp_lg_u32 s60, 2
    s_cbranch_scc1 Ltc2
    s_call_b64 s[28:29], Lstub2
    s_call_b64 s[28:29], Lstub6
Ltc2:
    s_cmp_lg_u32 s60, 3
    s_cbranch_scc1 Ltc3
    s_call_b64 s[28:29], Lstub3
Ltc3:
    s_branch LA2
LS:
    s_lshr_b32 s63, s64, 1
    s_mul_i32 s4, s63, 2097152
    s_lshl_b32 s68, s64, 2
    s_add_u32 s68, s68, s60
    v_lshlrev_b32 v5, 7, v0
    s_waitcnt lgkmcnt(0)
    s_add_u32 s56, s28, s4
    s_addc_u32 s57, s29, 0
    s_mov_b32 s58, 0x200000
    s_mov_b32 s59, 0x20000
    s_load_dword s100, s[12:13], 0
    s_load_dword s100, s[16:17], 0
    s_load_dword s100, s[20:21], 0
    s_load_dword s100, s[24:25], 0
    s_mov_b64 s[36:37], s[10:11]
    s_mov_b32 s38, 1204224
    s_mov_b32 s39, 0x20000
    s_mov_b64 s[40:41], s[12:13]
    s_mov_b32 s42, 401408
    s_mov_b32 s43, 0x20000
    s_mov_b64 s[44:45], s[16:17]
    s_mov_b32 s46, 1605632
    s_mov_b32 s47, 0x20000
    s_mov_b64 s[48:49], s[20:21]
    s_mov_b32 s50, 1605632
    s_mov_b32 s51, 0x20000
    s_and_b32 s72, s68, 7
    s_and_b32 s73, s68, 15
    s_mul_i32 s4, s72, 1024
    s_add_u32 s4, s4, 253952
    s_mov_b32 exec_lo, 0xff
    s_mov_b32 exec_hi, 0x0
    buffer_load_dword v1, v5, s[56:59], s4 offen sc1
    s_mul_i32 s4, s72, 256
    s_add_u32 s4, s4, 724992
    s_mov_b32 exec_lo, 0x3
    buffer_load_dword v1, v5, s[56:59], s4 offen sc1
    s_mul_i32 s4, s72, 512
    s_add_u32 s4, s4, 733184
    s_mov_b32 exec_lo, 0xf
    buffer_load_dword v1, v5, s[56:59], s4 offen sc1
    s_mov_b32 exec_lo, 0xffffffff
    s_mov_b32 exec_hi, 0xffffffff
    s_mul_i32 s4, s68, 7
    s_lshr_b32 s4, s4, 1
    s_mul_i32 s4, s4, 2688
    v_lshrrev_b32 v6, 3, v0
    v_mul_u32_u24 v6, 2688, v6
    v_and_b32 v7, 7, v0
    v_lshl_add_u32 v6, v7, 7, v6
    s_mov_b32 exec_lo, 0x7f7f7f7f
    s_mov_b32 exec_hi, 0x0
    buffer_load_dword v1, v6, s[36:39], s4 offen offset:1792
    s_mul_i32 s4, s68, 3200
    s_mov_b32 exec_lo, 0x1ffffff
    buffer_load_dword v1, v5, s[40:43], s4 offen
    s_mul_i32 s4, s68, 6272
    s_mov_b32 exec_lo, 0xffffffff
    s_mov_b32 exec_hi, 0x1ffff
    buffer_load_dword v1, v5, s[44:47], s4 offen
    s_mul_i32 s4, s68, 6272
    s_add_u32 s4, s4, 802816
    buffer_load_dword v1, v5, s[44:47], s4 offen
    s_mul_i32 s4, s73, 7168
    s_add_u32 s4, s4, 229376
    s_mov_b32 exec_hi, 0xffffff
    buffer_load_dword v1, v5, s[44:47], s4 offen
    s_mul_i32 s4, s73, 7168
    s_add_u32 s4, s4, 344064
    buffer_load_dword v1, v5, s[44:47], s4 offen
    s_mov_b32 exec_hi, 0xffffffff
    s_and_b32 s4, s64, 3
    s_mul_i32 s4, s4, 448
    s_lshl_b32 s5, s60, 3
    s_add_u32 s4, s4, s5
    v_lshrrev_b32 v10, 3, v0
    v_add_u32 v10, s4, v10
    v_and_b32 v11, 7, v0
    v_lshlrev_b32 v12, 7, v11
    s_movk_i32 s6, 896
    v_mad_u32_u24 v10, v10, s6, v12
    s_lshr_b32 s4, s64, 2
    v_add_u32 v11, s4, v11
    v_subrev_u32 v12, 7, v11
    v_min_u32 v11, v11, v12
    v_mul_u32_u24 v11, 57344, v11
    s_mov_b32 s6, 401408
    s_mov_b32 exec_lo, 0x7f7f7f7f
    s_mov_b32 exec_hi, 0x7f7f7f7f
    v_add_u32 v12, v10, v11
    buffer_load_dword v1, v12, s[48:51], 0 offen
    v_add_u32 v11, 28672, v11
    v_cmp_eq_u32 vcc, s6, v11
    s_nop 1
    v_cndmask_b32 v11, v11, 0, vcc
    v_add_u32 v12, v10, v11
    buffer_load_dword v1, v12, s[48:51], 0 offen
    v_add_u32 v11, 28672, v11
    v_cmp_eq_u32 vcc, s6, v11
    s_nop 1
    v_cndmask_b32 v11, v11, 0, vcc
    s_mul_i32 s4, s73, 7168
    s_add_u32 s4, s4, 458752
    s_mov_b32 exec_lo, 0xffffffff
    s_mov_b32 exec_hi, 0xffffff
    buffer_load_dword v1, v5, s[44:47], s4 offen
    s_mul_i32 s4, s73, 7168
    s_add_u32 s4, s4, 573440
    buffer_load_dword v1, v5, s[44:47], s4 offen
    s_mul_i32 s4, s73, 7168
    s_add_u32 s4, s4, 688128
    buffer_load_dword v1, v5, s[44:47], s4 offen
    s_mul_i32 s4, s73, 7168
    s_add_u32 s4, s4, 802816
    buffer_load_dword v1, v5, s[44:47], s4 offen
    s_mul_i32 s4, s73, 7168
    s_add_u32 s4, s4, 1146880
    buffer_load_dword v1, v5, s[44:47], s4 offen
    s_mul_i32 s4, s73, 7168
    s_add_u32 s4, s4, 1261568
    buffer_load_dword v1, v5, s[44:47], s4 offen
    s_mul_i32 s4, s73, 7168
    s_add_u32 s4, s4, 1376256
    buffer_load_dword v1, v5, s[44:47], s4 offen
    s_mul_i32 s4, s73, 7168
    s_add_u32 s4, s4, 1490944
    buffer_load_dword v1, v5, s[44:47], s4 offen
    s_mov_b32 exec_lo, 0x7f7f7f7f
    s_mov_b32 exec_hi, 0x7f7f7f7f
    s_mov_b32 s81, 12
LSl:
    v_add_u32 v12, v10, v11
    buffer_load_dword v1, v12, s[48:51], 0 offen
    v_add_u32 v11, 28672, v11
    v_cmp_eq_u32 vcc, s6, v11
    s_nop 1
    v_cndmask_b32 v11, v11, 0, vcc
    s_sub_u32 s81, s81, 1
    s_cmp_lg_u32 s81, 0
    s_cbranch_scc1 LSl
    s_endpgm
LB1:
    s_add_u32 s73, s72, 128
    s_cmp_eq_u32 s73, 896
    s_cselect_b32 s73, 0, s73
    s_add_u32 s74, s73, 128
    s_cmp_eq_u32 s74, 896
    s_cselect_b32 s74, 0, s74
    s_add_u32 s75, s74, 128
    s_cmp_eq_u32 s75, 896
    s_cselect_b32 s75, 0, s75
    s_add_u32 s76, s75, 128
    s_cmp_eq_u32 s76, 896
    s_cselect_b32 s76, 0, s76
    s_add_u32 s77, s76, 128
    s_cmp_eq_u32 s77, 896
    s_cselect_b32 s77, 0, s77
    s_add_u32 s78, s77, 128
    s_cmp_eq_u32 s78, 896
    s_cselect_b32 s78, 0, s78
    s_add_u32 m0, s79, 12288
    s_nop 0
    buffer_load_dwordx4 v2, s[32:35], s73 offen  lds
    s_add_u32 m0, s79, 13312
    s_nop 0
    buffer_load_dwordx4 v11, s[32:35], s73 offen  lds
    s_add_u32 m0, s80, 147456
    s_mul_i32 s3, s73, 1344
    buffer_load_dwordx4 v4, s[36:39], s3 offen  lds
    s_add_u32 m0, s80, 150656
    s_nop 0
    buffer_load_dwordx4 v4, s[36:39], s3 offen offset:896  lds
    s_add_u32 m0, s80, 155648
    s_add_u32 s3, s3, 86016
    buffer_load_dwordx4 v4, s[36:39], s3 offen  lds
    s_add_u32 m0, s80, 158848
    s_nop 0
    buffer_load_dwordx4 v4, s[36:39], s3 offen offset:896  lds
    s_mov_b64 s[40:41], s[12:13]
    s_mov_b32 s42, 401408
    s_mov_b32 s43, 0x20000
    s_mov_b64 s[44:45], s[16:17]
    s_mov_b32 s46, 1605632
    s_mov_b32 s47, 0x20000
    s_mov_b64 s[48:49], s[20:21]
    s_mov_b32 s50, 1605632
    s_mov_b32 s51, 0x20000
    s_lshr_b32 s63, s64, 1
    s_and_b32 s61, s64, 1
    s_mul_i32 s4, s63, 2097152
    s_waitcnt lgkmcnt(0)
    s_add_u32 s56, s28, s4
    s_addc_u32 s57, s29, 0
    s_mov_b32 s58, 0x200000
    s_mov_b32 s59, 0x20000
    s_mul_i32 s71, s61, 7
    s_add_u32 s71, s71, s62
    v_and_b32 v9, 15, v0
    v_lshrrev_b32 v10, 4, v0
    v_lshlrev_b32 v14, 4, v0
    v_mov_b32 v16, 0x3f803f80
    v_mov_b32 v17, 0x3f803f80
    v_mov_b32 v18, 0x3f803f80
    v_mov_b32 v19, 0x3f803f80
    v_lshrrev_b32 v5, 1, v9
    v_xor_b32 v5, v5, v10
    v_lshlrev_b32 v5, 4, v5
    v_lshl_add_u32 v5, v9, 7, v5
    v_add_u32 v88, s79, v5
    v_xor_b32 v89, 64, v88
    v_add_u32 v90, 40960, v88
    v_add_u32 v91, 40960, v89
    v_lshlrev_b32 v5, 2, v10
    v_sub_u32 v6, v9, v5
    v_cmp_eq_u32 s[84:85], 1, v6
    v_cmp_eq_u32 s[86:87], 2, v6
    v_cmp_eq_u32 s[88:89], 3, v6
    v_cmp_gt_u32 s[82:83], 4, v6
    v_lshrrev_b32 v5, 3, v0
    s_lshl_b32 s5, s60, 3
    v_add_u32 v5, s5, v5
    s_lshl_b32 s4, s62, 7
    v_lshl_add_u32 v6, v8, 4, s4
    s_movk_i32 s6, 896
    v_mad_u32_u24 v13, v5, s6, v6
    v_lshlrev_b32 v5, 2, v10
    v_xor_b32 v5, v5, v9
    s_lshl_b32 s4, s71, 8
    v_lshl_add_u32 v5, v5, 4, s4
    s_lshl_b32 s5, s60, 4
    v_add_u32 v6, s5, v10
    s_movk_i32 s6, 3584
    v_mad_u32_u24 v15, v6, s6, v5
    v_and_b32 v5, 3, v0
    s_lshl_b32 s4, s60, 2
    v_add_u32 v5, s4, v5
    v_and_b32 v6, 4, v0
    v_add_u32 v6, v6, v10
    v_lshrrev_b32 v7, 1, v5
    v_xor_b32 v6, v6, v7
    v_lshlrev_b32 v6, 4, v6
    v_lshl_add_u32 v6, v5, 7, v6
    v_lshrrev_b32 v7, 3, v9
    v_mul_u32_u24 v7, 10240, v7
    v_add_u32 v60, v6, v7
    s_lshl_b32 s4, s60, 6
    s_add_u32 s4, s4, 71744
    v_lshl_add_u32 v54, v9, 2, s4
    v_lshlrev_b32 v5, 2, v5
    v_add_u32 v5, 71680, v5
    s_mov_b64 s[90:91], 0xf0000
    v_cmp_gt_u32 s[92:93], 8, v9
    v_cndmask_b32 v54, v54, v5, s[90:91]
    s_lshl_b32 s4, s61, 2
    s_add_u32 s4, s4, s60
    s_lshl_b32 s4, s4, 3
    s_add_u32 s4, s4, s62
    s_lshl_b32 s4, s4, 11
    v_add_u32 v62, s4, v14
    s_mul_i32 s4, s60, 7
    s_add_u32 s4, s4, s62
    s_lshl_b32 s4, s4, 12
    s_lshl_b32 s5, s61, 8
    s_add_u32 s4, s4, s5
    s_add_u32 s4, s4, 131072
    s_lshl_b32 s5, s60, 3
    s_add_u32 s5, s5, s62
    s_lshl_b32 s5, s5, 1
    s_add_u32 s5, s5, s61
    s_lshl_b32 s5, s5, 7
    s_add_u32 s5, s5, 245760
    v_lshlrev_b32 v5, 9, v10
    v_lshl_add_u32 v5, v9, 4, v5
    v_add_u32 v63, s4, v5
    v_add_u32 v61, s5, v14
    s_lshl_b32 s4, s62, 12
    s_add_u32 s4, s4, s80
    s_mul_i32 s98, s61, 143360
    s_add_u32 s98, s98, s4
    s_lshl_b32 s99, s71, 12
    s_add_u32 s99, s99, s80
    v_accvgpr_write_b32 a0, -1
    v_accvgpr_write_b32 a1, -1
    v_accvgpr_write_b32 a2, -1
    v_accvgpr_write_b32 a3, -1
    s_and_b32 s68, s64, 3
    s_mul_i32 s68, s68, 7
    s_add_u32 s68, s68, s62
    s_lshl_b32 s68, s68, 2
    s_add_u32 s68, s68, s60
    v_lshlrev_b32 v124, 7, v0
    s_setprio 2
    s_waitcnt vmcnt(8)
    s_barrier
    ds_read_b128 v[20:23], v88 offset:2048
    ds_read_b128 v[24:27], v89 offset:2048
    ds_read_b128 v[92:95], v60 offset:0
    ds_read_b128 v[96:99], v60 offset:20480
    s_add_u32 m0, s79, 22528
    s_nop 0
    buffer_load_dwordx4 v2, s[32:35], s74 offen  lds
    s_add_u32 m0, s79, 23552
    s_nop 0
    buffer_load_dwordx4 v11, s[32:35], s74 offen  lds
    s_add_u32 m0, s79, 32768
    s_nop 0
    buffer_load_dwordx4 v2, s[32:35], s75 offen  lds
    s_waitcnt lgkmcnt(0)
    v_mfma_f32_16x16x32_bf16 v[36:39], v[20:23], v[20:23], 0
    v_mfma_f32_16x16x32_bf16 v[44:47], v[16:19], v[20:23], 0
    s_add_u32 m0, s79, 33792
    s_nop 0
    buffer_load_dwordx4 v11, s[32:35], s75 offen  lds
    v_mfma_f32_16x16x32_bf16 v[36:39], v[24:27], v[24:27], v[36:39]
    v_mfma_f32_16x16x32_bf16 v[44:47], v[16:19], v[24:27], v[44:47]
    s_branch Lsk0
Lstub0:
    s_setpc_b64 s[28:29]
Lsk0:
    s_add_u32 m0, s80, 131072
    s_mul_i32 s3, s74, 1344
    buffer_load_dwordx4 v4, s[36:39], s3 offen  lds
    v_mfma_f32_16x16x32_bf16 v[40:43], v[92:95], v[92:95], 0
    v_mfma_f32_16x16x32_bf16 v[48:51], v[16:19], v[92:95], 0
    s_add_u32 m0, s80, 134272
    s_nop 0
    buffer_load_dwordx4 v4, s[36:39], s3 offen offset:896  lds
    v_mfma_f32_16x16x32_bf16 v[40:43], v[96:99], v[96:99], v[40:43]
    v_mfma_f32_16x16x32_bf16 v[48:51], v[16:19], v[96:99], v[48:51]
    s_add_u32 m0, s80, 139264
    s_add_u32 s3, s3, 86016
    buffer_load_dwordx4 v4, s[36:39], s3 offen  lds
    s_add_u32 m0, s80, 142464
    s_nop 0
    buffer_load_dwordx4 v4, s[36:39], s3 offen offset:896  lds
    s_waitcnt vmcnt(8)
    s_barrier
    ds_read_b128 v[64:67], v88 offset:12288
    ds_read_b128 v[68:71], v89 offset:12288
    ds_read_b128 v[100:103], v60 offset:40960
    ds_read_b128 v[104:107], v60 offset:61440
    s_add_u32 m0, s79, 43008
    s_nop 0
    buffer_load_dwordx4 v2, s[32:35], s76 offen  lds
    s_add_u32 m0, s79, 44032
    s_nop 0
    buffer_load_dwordx4 v11, s[32:35], s76 offen  lds
    s_add_u32 m0, s79, 53248
    s_nop 0
    buffer_load_dwordx4 v2, s[32:35], s77 offen  lds
    s_waitcnt lgkmcnt(0)
    v_mfma_f32_16x16x32_bf16 v[36:39], v[64:67], v[64:67], v[36:39]
    v_mfma_f32_16x16x32_bf16 v[44:47], v[16:19], v[64:67], v[44:47]
    s_add_u32 m0, s79, 54272
    s_nop 0
    buffer_load_dwordx4 v11, s[32:35], s77 offen  lds
    v_mfma_f32_16x16x32_bf16 v[36:39], v[68:71], v[68:71], v[36:39]
    v_mfma_f32_16x16x32_bf16 v[44:47], v[16:19], v[68:71], v[44:47]
    s_add_u32 m0, s79, 63488
    s_nop 0
    buffer_load_dwordx4 v2, s[32:35], s78 offen  lds
    v_mfma_f32_16x16x32_bf16 v[40:43], v[100:103], v[100:103], v[40:43]
    v_mfma_f32_16x16x32_bf16 v[48:51], v[16:19], v[100:103], v[48:51]
    s_add_u32 m0, s79, 64512
    s_nop 0
    buffer_load_dwordx4 v11, s[32:35], s78 offen  lds
    v_cndmask_b32 v104, 0, v104, s[92:93]
    v_cndmask_b32 v105, 0, v105, s[92:93]
    v_cndmask_b32 v106, 0, v106, s[92:93]
    v_cndmask_b32 v107, 0, v107, s[92:93]
    s_nop 1
    v_mfma_f32_16x16x32_bf16 v[40:43], v[104:107], v[104:107], v[40:43]
    v_mfma_f32_16x16x32_bf16 v[48:51], v[16:19], v[104:107], v[48:51]
    s_add_u32 m0, s80, 114688
    s_mul_i32 s3, s75, 1344
    buffer_load_dwordx4 v4, s[36:39], s3 offen  lds
    s_add_u32 m0, s80, 117888
    s_nop 0
    buffer_load_dwordx4 v4, s[36:39], s3 offen offset:896  lds
    s_add_u32 m0, s80, 122880
    s_add_u32 s3, s3, 86016
    buffer_load_dwordx4 v4, s[36:39], s3 offen  lds
    s_add_u32 m0, s80, 126080
    s_nop 0
    buffer_load_dwordx4 v4, s[36:39], s3 offen offset:896  lds
    s_waitcnt vmcnt(10)
    s_barrier
    ds_read_b128 v[20:23], v88 offset:22528
    ds_read_b128 v[24:27], v89 offset:22528
    ds_read_b128 v[28:31], v88 offset:32768
    s_add_u32 m0, s80, 98304
    s_mul_i32 s3, s76, 1344
    buffer_load_dwordx4 v4, s[36:39], s3 offen  lds
    s_add_u32 m0, s80, 101504
    s_nop 0
    buffer_load_dwordx4 v4, s[36:39], s3 offen offset:896  lds
    s_add_u32 m0, s80, 106496
    s_add_u32 s3, s3, 86016
    buffer_load_dwordx4 v4, s[36:39], s3 offen  lds
    s_waitcnt lgkmcnt(0)
    v_mfma_f32_16x16x32_bf16 v[36:39], v[20:23], v[20:23], v[36:39]
    v_mfma_f32_16x16x32_bf16 v[44:47], v[16:19], v[20:23], v[44:47]
    s_add_u32 m0, s80, 109696
    s_nop 0
    buffer_load_dwordx4 v4, s[36:39], s3 offen offset:896  lds
    v_mfma_f32_16x16x32_bf16 v[36:39], v[24:27], v[24:27], v[36:39]
    v_mfma_f32_16x16x32_bf16 v[44:47], v[16:19], v[24:27], v[44:47]
    s_add_u32 m0, s80, 81920
    s_mul_i32 s3, s77, 1344
    buffer_load_dwordx4 v4, s[36:39], s3 offen  lds
    v_mfma_f32_16x16x32_bf16 v[36:39], v[28:31], v[28:31], v[36:39]
    v_mfma_f32_16x16x32_bf16 v[44:47], v[16:19], v[28:31], v[44:47]
    s_add_u32 m0, s80, 85120
    s_nop 0
    buffer_load_dwordx4 v4, s[36:39], s3 offen offset:896  lds
    v_cndmask_b32 v40, v40, v41, s[84:85]
    v_cndmask_b32 v40, v40, v42, s[86:87]
    s_add_u32 m0, s80, 90112
    s_add_u32 s3, s3, 86016
    buffer_load_dwordx4 v4, s[36:39], s3 offen  lds
    v_cndmask_b32 v40, v40, v43, s[88:89]
    v_cndmask_b32 v40, 0, v40, s[82:83]
    s_add_u32 m0, s80, 93312
    s_nop 0
    buffer_load_dwordx4 v4, s[36:39], s3 offen offset:896  lds
    v_mov_b32 v41, v40
    s_nop 1
    v_permlane16_swap_b32 v40, v41
    v_add_f32 v40, v40, v41
    v_mov_b32 v41, v40
    s_nop 1
    v_permlane32_swap_b32 v40, v41
    v_add_f32 v40, v40, v41
    s_nop 1
    v_add_f32_dpp v40, v40, v40 row_ror:4 row_mask:0xf bank_mask:0xf
    v_add_f32_dpp v48, v48, v48 row_ror:4 row_mask:0xf bank_mask:0xf
    s_nop 0
    v_add_f32_dpp v40, v40, v40 row_ror:8 row_mask:0xf bank_mask:0xf
    v_add_f32_dpp v48, v48, v48 row_ror:8 row_mask:0xf bank_mask:0xf
    s_waitcnt vmcnt(8)
    s_barrier
    ds_read_b128 v[64:67], v89 offset:32768
    ds_read_b128 v[68:71], v90 offset:2048
    ds_read_b128 v[72:75], v91 offset:2048
    s_add_u32 m0, s80, 147456
    s_mul_i32 s3, s78, 1344
    buffer_load_dwordx4 v4, s[36:39], s3 offen  lds
    s_add_u32 m0, s80, 150656
    s_nop 0
    buffer_load_dwordx4 v4, s[36:39], s3 offen offset:896  lds
    s_add_u32 m0, s80, 155648
    s_add_u32 s3, s3, 86016
    buffer_load_dwordx4 v4, s[36:39], s3 offen  lds
    s_waitcnt lgkmcnt(0)
    v_mfma_f32_16x16x32_bf16 v[36:39], v[64:67], v[64:67], v[36:39]
    v_mfma_f32_16x16x32_bf16 v[44:47], v[16:19], v[64:67], v[44:47]
    s_add_u32 m0, s80, 158848
    s_nop 0
    buffer_load_dwordx4 v4, s[36:39], s3 offen offset:896  lds
    v_mfma_f32_16x16x32_bf16 v[36:39], v[68:71], v[68:71], v[36:39]
    v_mfma_f32_16x16x32_bf16 v[44:47], v[16:19], v[68:71], v[44:47]
    s_add_u32 m0, s80, 71936
    s_mul_i32 s3, s78, 1344
    buffer_load_dwordx4 v4, s[36:39], s3 offen offset:1792  lds
    v_mfma_f32_16x16x32_bf16 v[36:39], v[72:75], v[72:75], v[36:39]
    v_mfma_f32_16x16x32_bf16 v[44:47], v[16:19], v[72:75], v[44:47]
    s_add_u32 m0, s80, 76032
    s_add_u32 s3, s3, 86016
    buffer_load_dwordx4 v4, s[36:39], s3 offen offset:1792  lds
    s_waitcnt vmcnt(10)
    s_barrier
    ds_read_b128 v[20:23], v90 offset:12288
    ds_read_b128 v[24:27], v91 offset:12288
    ds_read_b128 v[28:31], v90 offset:22528
    ds_read_b128 v[32:35], v91 offset:22528
    s_add_u32 m0, s80, 129280
    s_mul_i32 s3, s72, 1344
    buffer_load_dwordx4 v4, s[36:39], s3 offen offset:1792  lds
    s_add_u32 m0, s80, 133376
    s_add_u32 s3, s3, 86016
    buffer_load_dwordx4 v4, s[36:39], s3 offen offset:1792  lds
    s_add_u32 m0, s80, 137472
    s_mul_i32 s3, s73, 1344
    buffer_load_dwordx4 v4, s[36:39], s3 offen offset:1792  lds
    s_waitcnt lgkmcnt(0)
    v_mfma_f32_16x16x32_bf16 v[36:39], v[20:23], v[20:23], v[36:39]
    v_mfma_f32_16x16x32_bf16 v[44:47], v[16:19], v[20:23], v[44:47]
    s_add_u32 m0, s80, 141568
    s_add_u32 s3, s3, 86016
    buffer_load_dwordx4 v4, s[36:39], s3 offen offset:1792  lds
    v_mfma_f32_16x16x32_bf16 v[36:39], v[24:27], v[24:27], v[36:39]
    v_mfma_f32_16x16x32_bf16 v[44:47], v[16:19], v[24:27], v[44:47]
    buffer_store_dwordx4 a[0:3], v62, s[56:59], 0 offen offset:0 sc1
    v_mfma_f32_16x16x32_bf16 v[36:39], v[28:31], v[28:31], v[36:39]
    v_mfma_f32_16x16x32_bf16 v[44:47], v[16:19], v[28:31], v[44:47]
    buffer_store_dwordx4 a[0:3], v62, s[56:59], 0 offen offset:1024 sc1
    v_mfma_f32_16x16x32_bf16 v[36:39], v[32:35], v[32:35], v[36:39]
    v_mfma_f32_16x16x32_bf16 v[44:47], v[16:19], v[32:35], v[44:47]
    s_waitcnt vmcnt(12)
    s_barrier
    s_nop 4
    v_cndmask_b32 v36, v36, v37, s[84:85]
    v_cndmask_b32 v36, v36, v38, s[86:87]
    v_cndmask_b32 v36, v36, v39, s[88:89]
    v_cndmask_b32 v36, v36, v40, s[90:91]
    v_cndmask_b32 v44, v44, v48, s[90:91]
    v_mul_f32 v52, 3138537765, v44
    v_mul_f32 v53, 991054117, v36
    v_fma_f32 v53, -v52, v52, v53
    v_max_f32 v53, 0, v53
    v_add_f32 v53, 925353388, v53
    v_rsq_f32 v53, v53
    s_or_b64 exec, s[82:83], s[90:91]
    ds_write2_b32 v54, v52, v53 offset1:128
    s_mov_b64 exec, -1
    s_add_u32 m0, s80, 112896
    s_mul_i32 s3, s74, 1344
    buffer_load_dwordx4 v4, s[36:39], s3 offen offset:1792  lds
    s_add_u32 m0, s80, 116992
    s_add_u32 s3, s3, 86016
    buffer_load_dwordx4 v4, s[36:39], s3 offen offset:1792  lds
    s_add_u32 m0, s80, 121088
    s_mul_i32 s3, s75, 1344
    buffer_load_dwordx4 v4, s[36:39], s3 offen offset:1792  lds
    s_add_u32 m0, s80, 125184
    s_add_u32 s3, s3, 86016
    buffer_load_dwordx4 v4, s[36:39], s3 offen offset:1792  lds
    s_waitcnt lgkmcnt(0)
    s_waitcnt vmcnt(12)
    s_barrier
    s_add_u32 m0, s80, 96512
    s_mul_i32 s3, s76, 1344
    buffer_load_dwordx4 v4, s[36:39], s3 offen offset:1792  lds
    s_add_u32 m0, s80, 100608
    s_add_u32 s3, s3, 86016
    buffer_load_dwordx4 v4, s[36:39], s3 offen offset:1792  lds
    s_add_u32 m0, s80, 104704
    s_mul_i32 s3, s77, 1344
    buffer_load_dwordx4 v4, s[36:39], s3 offen offset:1792  lds
    s_add_u32 m0, s80, 108800
    s_add_u32 s3, s3, 86016
    buffer_load_dwordx4 v4, s[36:39], s3 offen offset:1792  lds
    s_mul_i32 s4, s68, 3584
    s_mov_b32 exec_lo, 268435455
    s_mov_b32 exec_hi, 0
    buffer_load_dword v1, v124, s[40:43], s4 offen
    s_mov_b64 exec, -1
    s_setprio 0
    s_lshl_b32 s75, s60, 12
    s_waitcnt vmcnt(1)
    s_barrier
    s_add_u32 m0, s75, 147456
    s_mov_b32 s3, 0
    buffer_load_dwordx4 v15, s[44:47], s3 offen  lds
    s_add_u32 m0, s75, 148480
    s_mov_b32 s3, 14336
    buffer_load_dwordx4 v15, s[44:47], s3 offen  lds
    s_add_u32 m0, s75, 149504
    s_mov_b32 s3, 28672
    buffer_load_dwordx4 v15, s[44:47], s3 offen  lds
    s_add_u32 m0, s75, 150528
    s_mov_b32 s3, 43008
    buffer_load_dwordx4 v15, s[44:47], s3 offen  lds
    s_add_u32 m0, s75, 81920
    s_mov_b32 s3, 917504
    buffer_load_dwordx4 v15, s[44:47], s3 offen  lds
    s_add_u32 m0, s75, 82944
    s_mov_b32 s3, 931840
    buffer_load_dwordx4 v15, s[44:47], s3 offen  lds
    s_add_u32 m0, s75, 83968
    s_mov_b32 s3, 946176
    buffer_load_dwordx4 v15, s[44:47], s3 offen  lds
    s_add_u32 m0, s75, 84992
    s_mov_b32 s3, 960512
    buffer_load_dwordx4 v15, s[44:47], s3 offen  lds
    s_barrier
    s_add_u32 m0, s75, 131072
    s_mov_b32 s3, 229376
    buffer_load_dwordx4 v15, s[44:47], s3 offen  lds
    s_add_u32 m0, s75, 132096
    s_mov_b32 s3, 243712
    buffer_load_dwordx4 v15, s[44:47], s3 offen  lds
    s_add_u32 m0, s75, 133120
    s_mov_b32 s3, 258048
    buffer_load_dwordx4 v15, s[44:47], s3 offen  lds
    s_add_u32 m0, s75, 134144
    s_mov_b32 s3, 272384
    buffer_load_dwordx4 v15, s[44:47], s3 offen  lds
    s_add_u32 m0, s80, 0
    s_mov_b32 s3, 0
    buffer_load_dwordx4 v13, s[40:43], s3 offen  lds
    s_add_u32 m0, s80, 4096
    s_mov_b32 s3, 28672
    buffer_load_dwordx4 v13, s[40:43], s3 offen  lds
    s_add_u32 m0, s80, 8192
    s_mov_b32 s3, 57344
    buffer_load_dwordx4 v13, s[40:43], s3 offen  lds
    s_add_u32 m0, s80, 12288
    s_mov_b32 s3, 86016
    buffer_load_dwordx4 v13, s[40:43], s3 offen  lds
    s_add_u32 m0, s80, 16384
    s_mov_b32 s3, 114688
    buffer_load_dwordx4 v13, s[40:43], s3 offen  lds
    s_mul_i32 s4, s60, 394240
    v_add_u32 v2, s4, v13
    s_mul_i32 s72, s60, 10240
    s_add_u32 s72, s72, 122880
    v_lshrrev_b32 v20, 2, v9
    v_and_b32 v21, 3, v0
    v_lshl_add_u32 v22, v10, 2, v20
    v_lshlrev_b32 v6, 7, v22
    v_lshl_add_u32 v6, v21, 3, v6
    v_add_u32 v6, s72, v6
    v_lshrrev_b32 v5, 1, v22
    v_and_b32 v5, 3, v5
    v_xor_b32 v7, 0, v5
    v_lshl_add_u32 v16, v7, 5, v6
    v_xor_b32 v7, 1, v5
    v_lshl_add_u32 v17, v7, 5, v6
    v_xor_b32 v7, 2, v5
    v_lshl_add_u32 v18, v7, 5, v6
    v_xor_b32 v7, 3, v5
    v_lshl_add_u32 v19, v7, 5, v6
    s_lshr_b32 s4, s64, 2
    s_add_u32 s4, s4, s62
    s_cmp_ge_u32 s4, 7
    s_cselect_b32 s5, 7, 0
    s_sub_u32 s4, s4, s5
    s_lshl_b32 s82, s4, 11
    s_add_u32 s83, s82, 1024
    s_cmp_eq_u32 s83, 14336
    s_cselect_b32 s83, 0, s83
    s_add_u32 s84, s83, 1024
    s_cmp_eq_u32 s84, 14336
    s_cselect_b32 s84, 0, s84
    s_add_u32 s85, s84, 1024
    s_cmp_eq_u32 s85, 14336
    s_cselect_b32 s85, 0, s85
    s_add_u32 s86, s85, 1024
    s_cmp_eq_u32 s86, 14336
    s_cselect_b32 s86, 0, s86
    s_add_u32 s87, s86, 1024
    s_cmp_eq_u32 s87, 14336
    s_cselect_b32 s87, 0, s87
    s_add_u32 s88, s87, 1024
    s_cmp_eq_u32 s88, 14336
    s_cselect_b32 s88, 0, s88
    s_add_u32 s89, s88, 1024
    s_cmp_eq_u32 s89, 14336
    s_cselect_b32 s89, 0, s89
    s_add_u32 s90, s89, 1024
    s_cmp_eq_u32 s90, 14336
    s_cselect_b32 s90, 0, s90
    s_add_u32 s91, s90, 1024
    s_cmp_eq_u32 s91, 14336
    s_cselect_b32 s91, 0, s91
    s_add_u32 s92, s91, 1024
    s_cmp_eq_u32 s92, 14336
    s_cselect_b32 s92, 0, s92
    s_add_u32 s93, s92, 1024
    s_cmp_eq_u32 s93, 14336
    s_cselect_b32 s93, 0, s93
    s_add_u32 s94, s93, 1024
    s_cmp_eq_u32 s94, 14336
    s_cselect_b32 s94, 0, s94
    s_add_u32 s95, s94, 1024
    s_cmp_eq_u32 s95, 14336
    s_cselect_b32 s95, 0, s95
    s_mul_i32 s4, s61, 224
    s_mul_i32 s5, s60, 14
    s_add_u32 s4, s4, s5
    s_lshl_b32 s4, s4, 10
    s_add_u32 s73, s4, 262144
    s_mul_i32 s79, s60, 7168
    s_load_dword s26, s[56:57], 724736
    s_waitcnt lgkmcnt(0)
    s_add_u32 s26, s26, 1
    s_mov_b32 s27, s26
    s_xor_b32 s74, s61, 0
    s_lshl_b32 s74, s74, 10
    s_add_u32 s74, s74, 725376
Lcf0:
    s_add_u32 s74, s74, 128
    s_and_b32 s4, s74, 896
    s_cbranch_scc0 Lcv0
    s_add_u32 s4, s74, 0
    s_load_dwordx16 s[8:23], s[56:57], s4
    s_waitcnt lgkmcnt(0)
    s_xor_b64 s[8:9], s[8:9], s[26:27]
    s_xor_b64 s[10:11], s[10:11], s[26:27]
    s_or_b64 s[8:9], s[8:9], s[10:11]
    s_xor_b64 s[12:13], s[12:13], s[26:27]
    s_or_b64 s[8:9], s[8:9], s[12:13]
    s_xor_b64 s[14:15], s[14:15], s[26:27]
    s_or_b64 s[8:9], s[8:9], s[14:15]
    s_xor_b64 s[16:17], s[16:17], s[26:27]
    s_or_b64 s[8:9], s[8:9], s[16:17]
    s_xor_b64 s[18:19], s[18:19], s[26:27]
    s_or_b64 s[8:9], s[8:9], s[18:19]
    s_xor_b64 s[20:21], s[20:21], s[26:27]
    s_or_b64 s[8:9], s[8:9], s[20:21]
    s_xor_b64 s[22:23], s[22:23], s[26:27]
    s_or_b64 s[8:9], s[8:9], s[22:23]
    s_cbranch_scc1 Lcf0
    s_add_u32 s4, s74, 64
    s_load_dwordx16 s[8:23], s[56:57], s4
    s_waitcnt lgkmcnt(0)
    s_xor_b64 s[8:9], s[8:9], s[26:27]
    s_xor_b64 s[10:11], s[10:11], s[26:27]
    s_or_b64 s[8:9], s[8:9], s[10:11]
    s_xor_b64 s[12:13], s[12:13], s[26:27]
    s_or_b64 s[8:9], s[8:9], s[12:13]
    s_xor_b64 s[14:15], s[14:15], s[26:27]
    s_or_b64 s[8:9], s[8:9], s[14:15]
    s_xor_b64 s[16:17], s[16:17], s[26:27]
    s_or_b64 s[8:9], s[8:9], s[16:17]
    s_xor_b64 s[18:19], s[18:19], s[26:27]
    s_or_b64 s[8:9], s[8:9], s[18:19]
    s_cbranch_scc1 Lcf0
Lck0:
    s_barrier
    s_add_u32 m0, s80, 20480
    s_mov_b32 s3, 143360
    buffer_load_dwordx4 v13, s[40:43], s3 offen  lds
    s_add_u32 m0, s80, 24576
    s_mov_b32 s3, 172032
    buffer_load_dwordx4 v13, s[40:43], s3 offen  lds
    s_add_u32 m0, s80, 28672
    s_mov_b32 s3, 200704
    buffer_load_dwordx4 v13, s[40:43], s3 offen  lds
    s_add_u32 m0, s80, 32768
    s_mov_b32 s3, 229376
    buffer_load_dwordx4 v13, s[40:43], s3 offen  lds
    s_add_u32 m0, s80, 36864
    s_mov_b32 s3, 258048
    buffer_load_dwordx4 v13, s[40:43], s3 offen  lds
    s_add_u32 m0, s80, 40960
    s_mov_b32 s3, 286720
    buffer_load_dwordx4 v13, s[40:43], s3 offen  lds
    s_add_u32 m0, s80, 45056
    s_mov_b32 s3, 315392
    buffer_load_dwordx4 v13, s[40:43], s3 offen  lds
    s_add_u32 m0, s80, 49152
    s_mov_b32 s3, 344064
    buffer_load_dwordx4 v13, s[40:43], s3 offen  lds
    s_add_u32 m0, s80, 53248
    s_mov_b32 s3, 372736
    buffer_load_dwordx4 v13, s[40:43], s3 offen  lds
    s_add_u32 m0, s75, 114688
    s_mov_b32 s3, 458752
    buffer_load_dwordx4 v15, s[44:47], s3 offen  lds
    s_add_u32 m0, s75, 115712
    s_mov_b32 s3, 473088
    buffer_load_dwordx4 v15, s[44:47], s3 offen  lds
    s_add_u32 m0, s75, 116736
    s_mov_b32 s3, 487424
    buffer_load_dwordx4 v15, s[44:47], s3 offen  lds
    s_add_u32 m0, s75, 117760
    s_mov_b32 s3, 501760
    buffer_load_dwordx4 v15, s[44:47], s3 offen  lds
    s_add_u32 m0, s75, 98304
    s_mov_b32 s3, 688128
    buffer_load_dwordx4 v15, s[44:47], s3 offen  lds
    s_add_u32 m0, s75, 99328
    s_mov_b32 s3, 702464
    buffer_load_dwordx4 v15, s[44:47], s3 offen  lds
    s_add_u32 m0, s75, 100352
    s_mov_b32 s3, 716800
    buffer_load_dwordx4 v15, s[44:47], s3 offen  lds
    s_add_u32 m0, s75, 101376
    s_mov_b32 s3, 731136
    buffer_load_dwordx4 v15, s[44:47], s3 offen  lds
    s_waitcnt vmcnt(0)
    s_barrier
    s_barrier
    s_add_u32 m0, s75, 65536
    s_mov_b32 s3, 1146880
    buffer_load_dwordx4 v15, s[44:47], s3 offen  lds
    s_add_u32 m0, s75, 66560
    s_mov_b32 s3, 1161216
    buffer_load_dwordx4 v15, s[44:47], s3 offen  lds
    s_add_u32 m0, s75, 67584
    s_mov_b32 s3, 1175552
    buffer_load_dwordx4 v15, s[44:47], s3 offen  lds
    s_add_u32 m0, s75, 68608
    s_mov_b32 s3, 1189888
    buffer_load_dwordx4 v15, s[44:47], s3 offen  lds
    s_add_u32 m0, s75, 98304
    s_mov_b32 s3, 1376256
    buffer_load_dwordx4 v15, s[44:47], s3 offen  lds
    s_add_u32 m0, s75, 99328
    s_mov_b32 s3, 1390592
    buffer_load_dwordx4 v15, s[44:47], s3 offen  lds
    s_add_u32 m0, s75, 100352
    s_mov_b32 s3, 1404928
    buffer_load_dwordx4 v15, s[44:47], s3 offen  lds
    s_add_u32 m0, s75, 101376
    s_mov_b32 s3, 1419264
    buffer_load_dwordx4 v15, s[44:47], s3 offen  lds
    s_add_u32 m0, s72, 0
    s_mul_i32 s3, s82, 28
    buffer_load_dwordx4 v2, s[48:51], s3 offen  lds
    s_add_u32 m0, s72, 1024
    s_add_u32 s3, s3, 14336
    buffer_load_dwordx4 v2, s[48:51], s3 offen  lds
    s_add_u32 m0, s72, 2048
    s_mul_i32 s3, s82, 28
    s_add_u32 s3, s3, 7168
    buffer_load_dwordx4 v2, s[48:51], s3 offen  lds
    s_add_u32 m0, s72, 3072
    s_add_u32 s3, s3, 14336
    buffer_load_dwordx4 v2, s[48:51], s3 offen  lds
    s_add_u32 m0, s72, 4096
    s_mul_i32 s3, s83, 28
    buffer_load_dwordx4 v2, s[48:51], s3 offen  lds
    s_add_u32 m0, s72, 5120
    s_add_u32 s3, s3, 14336
    buffer_load_dwordx4 v2, s[48:51], s3 offen  lds
    s_add_u32 m0, s72, 6144
    s_mul_i32 s3, s83, 28
    s_add_u32 s3, s3, 7168
    buffer_load_dwordx4 v2, s[48:51], s3 offen  lds
    s_add_u32 m0, s72, 7168
    s_add_u32 s3, s3, 14336
    buffer_load_dwordx4 v2, s[48:51], s3 offen  lds
    s_waitcnt vmcnt(8)
    s_barrier
    s_waitcnt vmcnt(6)
    ds_read_b64_tr_b16 a[0:1], v16 offset:0
    ds_read_b64_tr_b16 a[4:5], v17 offset:0
    ds_read_b64_tr_b16 a[8:9], v18 offset:0
    ds_read_b64_tr_b16 a[12:13], v19 offset:0
    s_add_u32 m0, s72, 8192
    s_mul_i32 s3, s84, 28
    buffer_load_dwordx4 v2, s[48:51], s3 offen  lds
    s_add_u32 m0, s72, 9216
    s_add_u32 s3, s3, 14336
    buffer_load_dwordx4 v2, s[48:51], s3 offen  lds
    s_waitcnt vmcnt(6)
    ds_read_b64_tr_b16 a[2:3], v16 offset:2048
    ds_read_b64_tr_b16 a[6:7], v17 offset:2048
    ds_read_b64_tr_b16 a[10:11], v18 offset:2048
    ds_read_b64_tr_b16 a[14:15], v19 offset:2048
    s_waitcnt lgkmcnt(4)
    s_add_u32 m0, s72, 0
    s_mul_i32 s3, s84, 28
    s_add_u32 s3, s3, 7168
    buffer_load_dwordx4 v2, s[48:51], s3 offen  lds
    s_add_u32 m0, s72, 1024
    s_add_u32 s3, s3, 14336
    buffer_load_dwordx4 v2, s[48:51], s3 offen  lds
    s_waitcnt vmcnt(6)
    ds_read_b64_tr_b16 a[16:17], v16 offset:4096
    ds_read_b64_tr_b16 a[20:21], v17 offset:4096
    ds_read_b64_tr_b16 a[24:25], v18 offset:4096
    ds_read_b64_tr_b16 a[28:29], v19 offset:4096
    s_waitcnt lgkmcnt(4)
    s_add_u32 m0, s72, 2048
    s_mul_i32 s3, s85, 28
    buffer_load_dwordx4 v2, s[48:51], s3 offen  lds
    s_add_u32 m0, s72, 3072
    s_add_u32 s3, s3, 14336
    buffer_load_dwordx4 v2, s[48:51], s3 offen  lds
    s_waitcnt vmcnt(6)
    ds_read_b64_tr_b16 a[18:19], v16 offset:6144
    ds_read_b64_tr_b16 a[22:23], v17 offset:6144
    ds_read_b64_tr_b16 a[26:27], v18 offset:6144
    ds_read_b64_tr_b16 a[30:31], v19 offset:6144
    s_waitcnt lgkmcnt(4)
    s_add_u32 m0, s72, 4096
    s_mul_i32 s3, s85, 28
    s_add_u32 s3, s3, 7168
    buffer_load_dwordx4 v2, s[48:51], s3 offen  lds
    s_add_u32 m0, s72, 5120
    s_add_u32 s3, s3, 14336
    buffer_load_dwordx4 v2, s[48:51], s3 offen  lds
    s_waitcnt vmcnt(6)
    ds_read_b64_tr_b16 a[32:33], v16 offset:8192
    ds_read_b64_tr_b16 a[36:37], v17 offset:8192
    ds_read_b64_tr_b16 a[40:41], v18 offset:8192
    ds_read_b64_tr_b16 a[44:45], v19 offset:8192
    s_waitcnt lgkmcnt(4)
    s_add_u32 m0, s72, 6144
    s_mul_i32 s3, s86, 28
    buffer_load_dwordx4 v2, s[48:51], s3 offen  lds
    s_add_u32 m0, s72, 7168
    s_add_u32 s3, s3, 14336
    buffer_load_dwordx4 v2, s[48:51], s3 offen  lds
    s_waitcnt vmcnt(6)
    ds_read_b64_tr_b16 a[34:35], v16 offset:0
    ds_read_b64_tr_b16 a[38:39], v17 offset:0
    ds_read_b64_tr_b16 a[42:43], v18 offset:0
    ds_read_b64_tr_b16 a[46:47], v19 offset:0
    s_waitcnt lgkmcnt(4)
    s_add_u32 m0, s72, 8192
    s_mul_i32 s3, s86, 28
    s_add_u32 s3, s3, 7168
    buffer_load_dwordx4 v2, s[48:51], s3 offen  lds
    s_add_u32 m0, s72, 9216
    s_add_u32 s3, s3, 14336
    buffer_load_dwordx4 v2, s[48:51], s3 offen  lds
    s_waitcnt vmcnt(6)
    ds_read_b64_tr_b16 a[48:49], v16 offset:2048
    ds_read_b64_tr_b16 a[52:53], v17 offset:2048
    ds_read_b64_tr_b16 a[56:57], v18 offset:2048
    ds_read_b64_tr_b16 a[60:61], v19 offset:2048
    s_waitcnt lgkmcnt(4)
    s_add_u32 m0, s72, 0
    s_mul_i32 s3, s87, 28
    buffer_load_dwordx4 v2, s[48:51], s3 offen  lds
    s_add_u32 m0, s72, 1024
    s_add_u32 s3, s3, 14336
    buffer_load_dwordx4 v2, s[48:51], s3 offen  lds
    s_branch Lsk1
Lstub1:
    s_setpc_b64 s[28:29]
Lsk1:
    s_waitcnt vmcnt(6)
    ds_read_b64_tr_b16 a[50:51], v16 offset:4096
    ds_read_b64_tr_b16 a[54:55], v17 offset:4096
    ds_read_b64_tr_b16 a[58:59], v18 offset:4096
    ds_read_b64_tr_b16 a[62:63], v19 offset:4096
    s_waitcnt lgkmcnt(4)
    s_add_u32 m0, s72, 2048
    s_mul_i32 s3, s87, 28
    s_add_u32 s3, s3, 7168
    buffer_load_dwordx4 v2, s[48:51], s3 offen  lds
    s_add_u32 m0, s72, 3072
    s_add_u32 s3, s3, 14336
    buffer_load_dwordx4 v2, s[48:51], s3 offen  lds
    s_waitcnt vmcnt(6)
    ds_read_b64_tr_b16 a[64:65], v16 offset:6144
    ds_read_b64_tr_b16 a[68:69], v17 offset:6144
    ds_read_b64_tr_b16 a[72:73], v18 offset:6144
    ds_read_b64_tr_b16 a[76:77], v19 offset:6144
    s_waitcnt lgkmcnt(4)
    s_add_u32 m0, s72, 4096
    s_mul_i32 s3, s88, 28
    buffer_load_dwordx4 v2, s[48:51], s3 offen  lds
    s_add_u32 m0, s72, 5120
    s_add_u32 s3, s3, 14336
    buffer_load_dwordx4 v2, s[48:51], s3 offen  lds
    s_waitcnt vmcnt(6)
    ds_read_b64_tr_b16 a[66:67], v16 offset:8192
    ds_read_b64_tr_b16 a[70:71], v17 offset:8192
    ds_read_b64_tr_b16 a[74:75], v18 offset:8192
    ds_read_b64_tr_b16 a[78:79], v19 offset:8192
    s_waitcnt lgkmcnt(4)
    s_add_u32 m0, s72, 6144
    s_mul_i32 s3, s88, 28
    s_add_u32 s3, s3, 7168
    buffer_load_dwordx4 v2, s[48:51], s3 offen  lds
    s_add_u32 m0, s72, 7168
    s_add_u32 s3, s3, 14336
    buffer_load_dwordx4 v2, s[48:51], s3 offen  lds
    s_lshl_b32 s5, s60, 11
    s_add_u32 m0, s5, 114688
    s_add_u32 s5, s5, 245760
    s_lshl_b32 s74, s60, 9
    s_add_u32 s74, s74, 260096
    s_load_dwordx16 s[8:23], s[56:57], s74
    s_branch Lgh
Lgfh:
    s_add_u32 s74, s74, 64
    s_and_b32 s4, s74, 511
    s_cbranch_scc0 Lgvh
    s_load_dwordx16 s[8:23], s[56:57], s74
Lgh:
    s_waitcnt lgkmcnt(0)
    s_xor_b64 s[8:9], s[8:9], s[26:27]
    s_xor_b64 s[10:11], s[10:11], s[26:27]
    s_or_b64 s[8:9], s[8:9], s[10:11]
    s_xor_b64 s[12:13], s[12:13], s[26:27]
    s_or_b64 s[8:9], s[8:9], s[12:13]
    s_xor_b64 s[14:15], s[14:15], s[26:27]
    s_or_b64 s[8:9], s[8:9], s[14:15]
    s_xor_b64 s[16:17], s[16:17], s[26:27]
    s_or_b64 s[8:9], s[8:9], s[16:17]
    s_xor_b64 s[18:19], s[18:19], s[26:27]
    s_or_b64 s[8:9], s[8:9], s[18:19]
    s_xor_b64 s[20:21], s[20:21], s[26:27]
    s_or_b64 s[8:9], s[8:9], s[20:21]
    s_cbranch_scc1 Lgfh
Lgkh:
    buffer_load_dwordx4 v14, s[56:59], s5 offen sc1 lds
    s_mov_b32 exec_hi, 0xffff
    buffer_load_dwordx4 v14, s[56:59], s5 offen offset:1024 sc1 lds
    s_mov_b64 exec, -1
    s_barrier
    s_barrier
    s_waitcnt vmcnt(0)
    s_barrier
    s_add_u32 m0, s79, 57344
    s_add_u32 s3, m0, 131072
    buffer_load_dwordx4 v14, s[56:59], s3 offen offset:0 sc1 lds
    buffer_load_dwordx4 v14, s[56:59], s3 offen offset:1024 sc1 lds
    buffer_load_dwordx4 v14, s[56:59], s3 offen offset:2048 sc1 lds
    buffer_load_dwordx4 v14, s[56:59], s3 offen offset:3072 sc1 lds
    s_add_u32 m0, s79, 61440
    s_add_u32 s3, m0, 131072
    buffer_load_dwordx4 v14, s[56:59], s3 offen offset:0 sc1 lds
    buffer_load_dwordx4 v14, s[56:59], s3 offen offset:1024 sc1 lds
    buffer_load_dwordx4 v14, s[56:59], s3 offen offset:2048 sc1 lds
    ds_read_b64_tr_b16 a[80:81], v16 offset:0
    ds_read_b64_tr_b16 a[84:85], v17 offset:0
    ds_read_b64_tr_b16 a[88:89], v18 offset:0
    ds_read_b64_tr_b16 a[92:93], v19 offset:0
    s_add_u32 m0, s72, 8192
    s_mul_i32 s3, s89, 28
    buffer_load_dwordx4 v2, s[48:51], s3 offen  lds
    s_add_u32 m0, s72, 9216
    s_add_u32 s3, s3, 14336
    buffer_load_dwordx4 v2, s[48:51], s3 offen  lds
    s_barrier
    s_add_u32 m0, s79, 86016
    s_add_u32 s3, m0, 131072
    buffer_load_dwordx4 v14, s[56:59], s3 offen offset:0 sc1 lds
    buffer_load_dwordx4 v14, s[56:59], s3 offen offset:1024 sc1 lds
    buffer_load_dwordx4 v14, s[56:59], s3 offen offset:2048 sc1 lds
    buffer_load_dwordx4 v14, s[56:59], s3 offen offset:3072 sc1 lds
    s_add_u32 m0, s79, 90112
    s_add_u32 s3, m0, 131072
    buffer_load_dwordx4 v14, s[56:59], s3 offen offset:0 sc1 lds
    buffer_load_dwordx4 v14, s[56:59], s3 offen offset:1024 sc1 lds
    buffer_load_dwordx4 v14, s[56:59], s3 offen offset:2048 sc1 lds
    ds_read_b64_tr_b16 a[82:83], v16 offset:2048
    ds_read_b64_tr_b16 a[86:87], v17 offset:2048
    ds_read_b64_tr_b16 a[90:91], v18 offset:2048
    ds_read_b64_tr_b16 a[94:95], v19 offset:2048
    s_waitcnt lgkmcnt(4)
    s_add_u32 m0, s72, 0
    s_mul_i32 s3, s89, 28
    s_add_u32 s3, s3, 7168
    buffer_load_dwordx4 v2, s[48:51], s3 offen  lds
    s_add_u32 m0, s72, 1024
    s_add_u32 s3, s3, 14336
    buffer_load_dwordx4 v2, s[48:51], s3 offen  lds
    ds_read_b64_tr_b16 a[96:97], v16 offset:4096
    ds_read_b64_tr_b16 a[100:101], v17 offset:4096
    ds_read_b64_tr_b16 a[104:105], v18 offset:4096
    ds_read_b64_tr_b16 a[108:109], v19 offset:4096
    s_waitcnt lgkmcnt(4)
    s_add_u32 m0, s72, 2048
    s_mul_i32 s3, s90, 28
    buffer_load_dwordx4 v2, s[48:51], s3 offen  lds
    s_add_u32 m0, s72, 3072
    s_add_u32 s3, s3, 14336
    buffer_load_dwordx4 v2, s[48:51], s3 offen  lds
    ds_read_b64_tr_b16 a[98:99], v16 offset:6144
    ds_read_b64_tr_b16 a[102:103], v17 offset:6144
    ds_read_b64_tr_b16 a[106:107], v18 offset:6144
    ds_read_b64_tr_b16 a[110:111], v19 offset:6144
    s_waitcnt lgkmcnt(4)
    s_add_u32 m0, s72, 4096
    s_mul_i32 s3, s90, 28
    s_add_u32 s3, s3, 7168
    buffer_load_dwordx4 v2, s[48:51], s3 offen  lds
    s_add_u32 m0, s72, 5120
    s_add_u32 s3, s3, 14336
    buffer_load_dwordx4 v2, s[48:51], s3 offen  lds
    s_waitcnt vmcnt(6)
    s_barrier
    s_lshl_b32 s76, s60, 8
    v_mov_b32 v46, v2
    v_add_u32 v0, s75, v14
    s_mul_i32 s4, s60, 4352
    v_lshl_add_u32 v1, v10, 4, s4
    v_add_u32 v1, v1, v14
    v_mov_b32 v2, v16
    v_mov_b32 v3, v17
    v_mov_b32 v4, v18
    v_mov_b32 v5, v19
    s_sub_u32 s4, s73, s75
    s_add_u32 s40, s56, s4
    s_addc_u32 s41, s57, 0
    s_mov_b32 s42, 0x10000
    s_mul_i32 s4, s60, 3840
    s_sub_u32 s4, 733184, s4
    s_add_u32 s44, s56, s4
    s_addc_u32 s45, s57, 0
    s_mov_b32 s46, 0x10000
    ds_read_b64_tr_b16 a[112:113], v2 offset:8192
    ds_read_b64_tr_b16 a[116:117], v3 offset:8192
    ds_read_b64_tr_b16 a[120:121], v4 offset:8192
    ds_read_b64_tr_b16 a[124:125], v5 offset:8192
    s_waitcnt lgkmcnt(4)
    s_add_u32 m0, s72, 6144
    s_mul_i32 s3, s91, 28
    buffer_load_dwordx4 v46, s[48:51], s3 offen  lds
    s_add_u32 m0, s72, 7168
    s_add_u32 s3, s3, 14336
    buffer_load_dwordx4 v46, s[48:51], s3 offen  lds
    s_waitcnt vmcnt(6)
    ds_read_b64_tr_b16 a[114:115], v2 offset:0
    ds_read_b64_tr_b16 a[118:119], v3 offset:0
    ds_read_b64_tr_b16 a[122:123], v4 offset:0
    ds_read_b64_tr_b16 a[126:127], v5 offset:0
    s_waitcnt lgkmcnt(4)
    s_add_u32 m0, s72, 8192
    s_mul_i32 s3, s91, 28
    s_add_u32 s3, s3, 7168
    buffer_load_dwordx4 v46, s[48:51], s3 offen  lds
    s_add_u32 m0, s72, 9216
    s_add_u32 s3, s3, 14336
    buffer_load_dwordx4 v46, s[48:51], s3 offen  lds
    s_waitcnt vmcnt(6)
    ds_read_b64_tr_b16 v[78:79], v2 offset:2048
    ds_read_b64_tr_b16 v[82:83], v3 offset:2048
    ds_read_b64_tr_b16 v[86:87], v4 offset:2048
    ds_read_b64_tr_b16 v[90:91], v5 offset:2048
    s_waitcnt lgkmcnt(4)
    s_add_u32 m0, s72, 0
    s_mul_i32 s3, s92, 28
    buffer_load_dwordx4 v46, s[48:51], s3 offen  lds
    s_add_u32 m0, s72, 1024
    s_add_u32 s3, s3, 14336
    buffer_load_dwordx4 v46, s[48:51], s3 offen  lds
    s_waitcnt vmcnt(6)
    ds_read_b64_tr_b16 v[80:81], v2 offset:4096
    ds_read_b64_tr_b16 v[84:85], v3 offset:4096
    ds_read_b64_tr_b16 v[88:89], v4 offset:4096
    ds_read_b64_tr_b16 v[92:93], v5 offset:4096
    s_waitcnt lgkmcnt(4)
    s_add_u32 m0, s72, 2048
    s_mul_i32 s3, s92, 28
    s_add_u32 s3, s3, 7168
    buffer_load_dwordx4 v46, s[48:51], s3 offen  lds
    s_add_u32 m0, s72, 3072
    s_add_u32 s3, s3, 14336
    buffer_load_dwordx4 v46, s[48:51], s3 offen  lds
    s_waitcnt vmcnt(6)
    ds_read_b64_tr_b16 v[94:95], v2 offset:6144
    ds_read_b64_tr_b16 v[98:99], v3 offset:6144
    ds_read_b64_tr_b16 v[102:103], v4 offset:6144
    ds_read_b64_tr_b16 v[106:107], v5 offset:6144
    s_waitcnt lgkmcnt(4)
    s_add_u32 m0, s72, 4096
    s_mul_i32 s3, s93, 28
    buffer_load_dwordx4 v46, s[48:51], s3 offen  lds
    s_add_u32 m0, s72, 5120
    s_add_u32 s3, s3, 14336
    buffer_load_dwordx4 v46, s[48:51], s3 offen  lds
    s_waitcnt vmcnt(6)
    ds_read_b64_tr_b16 v[96:97], v2 offset:8192
    ds_read_b64_tr_b16 v[100:101], v3 offset:8192
    ds_read_b64_tr_b16 v[104:105], v4 offset:8192
    ds_read_b64_tr_b16 v[108:109], v5 offset:8192
    s_waitcnt lgkmcnt(4)
    s_add_u32 m0, s72, 6144
    s_mul_i32 s3, s93, 28
    s_add_u32 s3, s3, 7168
    buffer_load_dwordx4 v46, s[48:51], s3 offen  lds
    s_add_u32 m0, s72, 7168
    s_add_u32 s3, s3, 14336
    buffer_load_dwordx4 v46, s[48:51], s3 offen  lds
    s_waitcnt vmcnt(6)
    ds_read_b64_tr_b16 v[110:111], v2 offset:0
    ds_read_b64_tr_b16 v[114:115], v3 offset:0
    ds_read_b64_tr_b16 v[118:119], v4 offset:0
    ds_read_b64_tr_b16 v[122:123], v5 offset:0
    s_waitcnt lgkmcnt(4)
    s_add_u32 m0, s72, 8192
    s_mul_i32 s3, s94, 28
    buffer_load_dwordx4 v46, s[48:51], s3 offen  lds
    s_add_u32 m0, s72, 9216
    s_add_u32 s3, s3, 14336
    buffer_load_dwordx4 v46, s[48:51], s3 offen  lds
    s_waitcnt vmcnt(6)
    ds_read_b64_tr_b16 v[112:113], v2 offset:2048
    ds_read_b64_tr_b16 v[116:117], v3 offset:2048
    ds_read_b64_tr_b16 v[120:121], v4 offset:2048
    ds_read_b64_tr_b16 v[124:125], v5 offset:2048
    s_waitcnt lgkmcnt(4)
    s_add_u32 m0, s72, 0
    s_mul_i32 s3, s94, 28
    s_add_u32 s3, s3, 7168
    buffer_load_dwordx4 v46, s[48:51], s3 offen  lds
    s_add_u32 m0, s72, 1024
    s_add_u32 s3, s3, 14336
    buffer_load_dwordx4 v46, s[48:51], s3 offen  lds
    s_add_u32 s74, s76, 253952
    s_load_dwordx16 s[8:23], s[56:57], s74
    s_setprio 1
    s_branch Lg0
Lgf0:
    s_add_u32 s74, s74, 64
    s_and_b32 s4, s74, 255
    s_cbranch_scc0 Lgv0
    s_load_dwordx16 s[8:23], s[56:57], s74
Lg0:
    s_waitcnt lgkmcnt(0)
    s_xor_b64 s[8:9], s[8:9], s[26:27]
    s_xor_b64 s[10:11], s[10:11], s[26:27]
    s_or_b64 s[8:9], s[8:9], s[10:11]
    s_xor_b64 s[12:13], s[12:13], s[26:27]
    s_or_b64 s[8:9], s[8:9], s[12:13]
    s_xor_b64 s[14:15], s[14:15], s[26:27]
    s_or_b64 s[8:9], s[8:9], s[14:15]
    s_xor_b64 s[16:17], s[16:17], s[26:27]
    s_or_b64 s[8:9], s[8:9], s[16:17]
    s_xor_b64 s[18:19], s[18:19], s[26:27]
    s_or_b64 s[8:9], s[8:9], s[18:19]
    s_xor_b64 s[20:21], s[20:21], s[26:27]
    s_or_b64 s[8:9], s[8:9], s[20:21]
    s_cbranch_scc1 Lgf0
Lgk0:
    buffer_load_dwordx4 v[6:9], v0, s[40:43], s82 offen sc1
    buffer_load_dwordx4 v[10:13], v0, s[40:43], s83 offen sc1
    buffer_load_dwordx4 v[14:17], v0, s[40:43], s84 offen sc1
    buffer_load_dwordx4 v[18:21], v0, s[40:43], s85 offen sc1
    buffer_load_dwordx4 v[22:25], v0, s[40:43], s86 offen sc1
    buffer_load_dwordx4 v[26:29], v0, s[40:43], s87 offen sc1
    buffer_load_dwordx4 v[30:33], v0, s[40:43], s88 offen sc1
    buffer_load_dwordx4 v[34:37], v0, s[40:43], s93 offen sc1
    buffer_load_dwordx4 v[38:41], v0, s[40:43], s89 offen sc1
    buffer_load_dwordx4 v[42:45], v0, s[40:43], s90 offen sc1
    s_waitcnt vmcnt(16)
    ds_read_b64_tr_b16 v[62:63], v2 offset:4096
    ds_read_b64_tr_b16 v[66:67], v3 offset:4096
    ds_read_b64_tr_b16 v[70:71], v4 offset:4096
    ds_read_b64_tr_b16 v[74:75], v5 offset:4096
    s_add_u32 m0, s72, 2048
    s_mul_i32 s3, s95, 28
    buffer_load_dwordx4 v46, s[48:51], s3 offen  lds
    s_add_u32 m0, s72, 3072
    s_add_u32 s3, s3, 14336
    buffer_load_dwordx4 v46, s[48:51], s3 offen  lds
    s_waitcnt vmcnt(16)
    ds_read_b64_tr_b16 v[64:65], v2 offset:6144
    ds_read_b64_tr_b16 v[68:69], v3 offset:6144
    ds_read_b64_tr_b16 v[72:73], v4 offset:6144
    ds_read_b64_tr_b16 v[76:77], v5 offset:6144
    s_waitcnt lgkmcnt(4)
    s_add_u32 m0, s72, 4096
    s_mul_i32 s3, s95, 28
    s_add_u32 s3, s3, 7168
    buffer_load_dwordx4 v46, s[48:51], s3 offen  lds
    s_add_u32 m0, s72, 5120
    s_add_u32 s3, s3, 14336
    buffer_load_dwordx4 v46, s[48:51], s3 offen  lds
    s_waitcnt lgkmcnt(0)
    ds_write_b128 v0, v[62:65] offset:34816
    ds_write_b128 v0, v[66:69] offset:35840
    ds_write_b128 v0, v[70:73] offset:36864
    ds_write_b128 v0, v[74:77] offset:37888
    s_waitcnt vmcnt(13)
    v_mfma_f32_16x16x32_bf16 v[46:49], a[0:3], v[6:9], 0
    v_mfma_f32_16x16x32_bf16 v[50:53], a[4:7], v[6:9], 0
    v_mfma_f32_16x16x32_bf16 v[54:57], a[8:11], v[6:9], 0
    v_mfma_f32_16x16x32_bf16 v[58:61], a[12:15], v[6:9], 0
    s_waitcnt vmcnt(12)
    v_mfma_f32_16x16x32_bf16 v[46:49], a[16:19], v[10:13], v[46:49]
    buffer_load_dwordx4 v[6:9], v0, s[40:43], s94 offen sc1
    v_mfma_f32_16x16x32_bf16 v[50:53], a[20:23], v[10:13], v[50:53]
    v_mfma_f32_16x16x32_bf16 v[54:57], a[24:27], v[10:13], v[54:57]
    v_mfma_f32_16x16x32_bf16 v[58:61], a[28:31], v[10:13], v[58:61]
    s_waitcnt vmcnt(12)
    v_mfma_f32_16x16x32_bf16 v[46:49], a[32:35], v[14:17], v[46:49]
    buffer_load_dwordx4 v[10:13], v0, s[40:43], s91 offen sc1
    v_mfma_f32_16x16x32_bf16 v[50:53], a[36:39], v[14:17], v[50:53]
    s_add_u32 s74, s76, 254976
    s_load_dwordx16 s[8:23], s[56:57], s74
    v_mfma_f32_16x16x32_bf16 v[54:57], a[40:43], v[14:17], v[54:57]
    v_mfma_f32_16x16x32_bf16 v[58:61], a[44:47], v[14:17], v[58:61]
    s_waitcnt vmcnt(12)
    v_mfma_f32_16x16x32_bf16 v[46:49], a[48:51], v[18:21], v[46:49]
    buffer_load_dwordx4 v[14:17], v0, s[40:43], s92 offen sc1
    v_mfma_f32_16x16x32_bf16 v[50:53], a[52:55], v[18:21], v[50:53]
    v_mfma_f32_16x16x32_bf16 v[54:57], a[56:59], v[18:21], v[54:57]
    v_mfma_f32_16x16x32_bf16 v[58:61], a[60:63], v[18:21], v[58:61]
    s_waitcnt vmcnt(12)
    v_mfma_f32_16x16x32_bf16 v[46:49], a[64:67], v[22:25], v[46:49]
    buffer_load_dwordx4 v[18:21], v0, s[40:43], s95 offen sc1
    v_mfma_f32_16x16x32_bf16 v[50:53], a[68:71], v[22:25], v[50:53]
    v_mfma_f32_16x16x32_bf16 v[54:57], a[72:75], v[22:25], v[54:57]
    v_mfma_f32_16x16x32_bf16 v[58:61], a[76:79], v[22:25], v[58:61]
    s_waitcnt vmcnt(12)
    v_mfma_f32_16x16x32_bf16 v[46:49], a[80:83], v[26:29], v[46:49]
    s_branch Lg1
Lgf1:
    s_add_u32 s74, s74, 64
    s_and_b32 s4, s74, 255
    s_cbranch_scc0 Lgv1
    s_load_dwordx16 s[8:23], s[56:57], s74
Lg1:
    s_waitcnt lgkmcnt(0)
    s_xor_b64 s[8:9], s[8:9], s[26:27]
    s_xor_b64 s[10:11], s[10:11], s[26:27]
    s_or_b64 s[8:9], s[8:9], s[10:11]
    s_xor_b64 s[12:13], s[12:13], s[26:27]
    s_or_b64 s[8:9], s[8:9], s[12:13]
    s_xor_b64 s[14:15], s[14:15], s[26:27]
    s_or_b64 s[8:9], s[8:9], s[14:15]
    s_xor_b64 s[16:17], s[16:17], s[26:27]
    s_or_b64 s[8:9], s[8:9], s[16:17]
    s_xor_b64 s[18:19], s[18:19], s[26:27]
    s_or_b64 s[8:9], s[8:9], s[18:19]
    s_xor_b64 s[20:21], s[20:21], s[26:27]
    s_or_b64 s[8:9], s[8:9], s[20:21]
    s_cbranch_scc1 Lgf1
Lgk1:
    s_add_u32 s40, s40, 57344
    s_addc_u32 s41, s41, 0
    buffer_load_dwordx4 v[22:25], v0, s[40:43], s82 offen sc1
    v_mfma_f32_16x16x32_bf16 v[50:53], a[84:87], v[26:29], v[50:53]
    v_mfma_f32_16x16x32_bf16 v[54:57], a[88:91], v[26:29], v[54:57]
    v_mfma_f32_16x16x32_bf16 v[58:61], a[92:95], v[26:29], v[58:61]
    s_waitcnt vmcnt(12)
    v_mfma_f32_16x16x32_bf16 v[46:49], a[96:99], v[30:33], v[46:49]
    buffer_load_dwordx4 v[26:29], v0, s[40:43], s83 offen sc1
    v_mfma_f32_16x16x32_bf16 v[50:53], a[100:103], v[30:33], v[50:53]
    v_mfma_f32_16x16x32_bf16 v[54:57], a[104:107], v[30:33], v[54:57]
    v_mfma_f32_16x16x32_bf16 v[58:61], a[108:111], v[30:33], v[58:61]
    s_waitcnt vmcnt(12)
    v_mfma_f32_16x16x32_bf16 v[46:49], v[62:65], v[34:37], v[46:49]
    buffer_load_dwordx4 v[30:33], v0, s[40:43], s84 offen sc1
    v_mfma_f32_16x16x32_bf16 v[50:53], v[66:69], v[34:37], v[50:53]
    v_mfma_f32_16x16x32_bf16 v[54:57], v[70:73], v[34:37], v[54:57]
    v_mfma_f32_16x16x32_bf16 v[58:61], v[74:77], v[34:37], v[58:61]
    s_waitcnt vmcnt(12)
    v_mfma_f32_16x16x32_bf16 v[46:49], a[112:115], v[38:41], v[46:49]
    buffer_load_dwordx4 v[34:37], v0, s[40:43], s85 offen sc1
    v_mfma_f32_16x16x32_bf16 v[50:53], a[116:119], v[38:41], v[50:53]
    ds_read_b64_tr_b16 v[62:63], v2 offset:8192
    ds_read_b64_tr_b16 v[64:65], v2 offset:0
    ds_read_b64_tr_b16 v[66:67], v3 offset:8192
    v_mfma_f32_16x16x32_bf16 v[54:57], a[120:123], v[38:41], v[54:57]
    ds_read_b64_tr_b16 v[68:69], v3 offset:0
    ds_read_b64_tr_b16 v[70:71], v4 offset:8192
    ds_read_b64_tr_b16 v[72:73], v4 offset:0
    v_mfma_f32_16x16x32_bf16 v[58:61], a[124:127], v[38:41], v[58:61]
    ds_read_b64_tr_b16 v[74:75], v5 offset:8192
    ds_read_b64_tr_b16 v[76:77], v5 offset:0
    s_waitcnt vmcnt(12)
    v_mfma_f32_16x16x32_bf16 v[46:49], v[78:81], v[42:45], v[46:49]
    buffer_load_dwordx4 v[38:41], v0, s[40:43], s86 offen sc1
    v_mfma_f32_16x16x32_bf16 v[50:53], v[82:85], v[42:45], v[50:53]
    v_mfma_f32_16x16x32_bf16 v[54:57], v[86:89], v[42:45], v[54:57]
    v_mfma_f32_16x16x32_bf16 v[58:61], v[90:93], v[42:45], v[58:61]
    s_waitcnt vmcnt(8) lgkmcnt(0)
    v_mfma_f32_16x16x32_bf16 v[46:49], v[62:65], v[6:9], v[46:49]
    buffer_load_dwordx4 v[42:45], v0, s[40:43], s87 offen sc1
    v_mfma_f32_16x16x32_bf16 v[50:53], v[66:69], v[6:9], v[50:53]
    v_mfma_f32_16x16x32_bf16 v[54:57], v[70:73], v[6:9], v[54:57]
    v_mfma_f32_16x16x32_bf16 v[58:61], v[74:77], v[6:9], v[58:61]
    s_waitcnt vmcnt(8)
    v_mfma_f32_16x16x32_bf16 v[46:49], v[94:97], v[10:13], v[46:49]
    buffer_load_dwordx4 v[6:9], v0, s[40:43], s88 offen sc1
    v_mfma_f32_16x16x32_bf16 v[50:53], v[98:101], v[10:13], v[50:53]
    s_mov_b64 exec, 0x3fff
    buffer_load_dword v127, v0, s[44:47], 0 offen offset:2048 sc1
    s_mov_b64 exec, -1
    ds_read_b64_tr_b16 v[62:63], v2 offset:2048
    ds_read_b64_tr_b16 v[64:65], v2 offset:4096
    ds_read_b64_tr_b16 v[66:67], v3 offset:2048
    v_mfma_f32_16x16x32_bf16 v[54:57], v[102:105], v[10:13], v[54:57]
    ds_read_b64_tr_b16 v[68:69], v3 offset:4096
    ds_read_b64_tr_b16 v[70:71], v4 offset:2048
    ds_read_b64_tr_b16 v[72:73], v4 offset:4096
    v_mfma_f32_16x16x32_bf16 v[58:61], v[106:109], v[10:13], v[58:61]
    ds_read_b64_tr_b16 v[74:75], v5 offset:2048
    ds_read_b64_tr_b16 v[76:77], v5 offset:4096
    s_waitcnt vmcnt(9)
    v_mfma_f32_16x16x32_bf16 v[46:49], v[110:113], v[14:17], v[46:49]
    buffer_load_dwordx4 v[10:13], v0, s[40:43], s93 offen sc1
    v_mfma_f32_16x16x32_bf16 v[50:53], v[114:117], v[14:17], v[50:53]
    v_mfma_f32_16x16x32_bf16 v[54:57], v[118:121], v[14:17], v[54:57]
    v_mfma_f32_16x16x32_bf16 v[58:61], v[122:125], v[14:17], v[58:61]
    s_waitcnt vmcnt(9) lgkmcnt(0)
    v_mfma_f32_16x16x32_bf16 v[46:49], v[62:65], v[18:21], v[46:49]
    buffer_load_dwordx4 v[14:17], v0, s[40:43], s89 offen sc1
    v_mfma_f32_16x16x32_bf16 v[50:53], v[66:69], v[18:21], v[50:53]
    v_mfma_f32_16x16x32_bf16 v[54:57], v[70:73], v[18:21], v[54:57]
    v_mfma_f32_16x16x32_bf16 v[58:61], v[74:77], v[18:21], v[58:61]
    s_waitcnt vmcnt(9)
    v_mfma_f32_16x16x32_bf16 v[62:65], a[0:3], v[22:25], 0
    buffer_load_dwordx4 v[18:21], v0, s[40:43], s90 offen sc1
    v_mfma_f32_16x16x32_bf16 v[66:69], a[4:7], v[22:25], 0
    v_mfma_f32_16x16x32_bf16 v[70:73], a[8:11], v[22:25], 0
    ds_write_b128 v1, v[46:49] offset:0
    v_mfma_f32_16x16x32_bf16 v[74:77], a[12:15], v[22:25], 0
    s_waitcnt vmcnt(9)
    v_mfma_f32_16x16x32_bf16 v[62:65], a[16:19], v[26:29], v[62:65]
    buffer_load_dwordx4 v[22:25], v0, s[40:43], s94 offen sc1
    v_mfma_f32_16x16x32_bf16 v[66:69], a[20:23], v[26:29], v[66:69]
    v_mfma_f32_16x16x32_bf16 v[70:73], a[24:27], v[26:29], v[70:73]
    v_mfma_f32_16x16x32_bf16 v[74:77], a[28:31], v[26:29], v[74:77]
    s_waitcnt vmcnt(9)
    v_mfma_f32_16x16x32_bf16 v[62:65], a[32:35], v[30:33], v[62:65]
    buffer_load_dwordx4 v[26:29], v0, s[40:43], s91 offen sc1
    v_mfma_f32_16x16x32_bf16 v[66:69], a[36:39], v[30:33], v[66:69]
    ds_write_b128 v1, v[50:53] offset:1088
    v_mfma_f32_16x16x32_bf16 v[70:73], a[40:43], v[30:33], v[70:73]
    v_mfma_f32_16x16x32_bf16 v[74:77], a[44:47], v[30:33], v[74:77]
    s_waitcnt vmcnt(9)
    v_mfma_f32_16x16x32_bf16 v[62:65], a[48:51], v[34:37], v[62:65]
    buffer_load_dwordx4 v[30:33], v0, s[40:43], s92 offen sc1
    v_mfma_f32_16x16x32_bf16 v[66:69], a[52:55], v[34:37], v[66:69]
    ds_write_b128 v1, v[54:57] offset:2176
    v_mfma_f32_16x16x32_bf16 v[70:73], a[56:59], v[34:37], v[70:73]
    v_mfma_f32_16x16x32_bf16 v[74:77], a[60:63], v[34:37], v[74:77]
    s_waitcnt vmcnt(9)
    v_mfma_f32_16x16x32_bf16 v[62:65], a[64:67], v[38:41], v[62:65]
    buffer_load_dwordx4 v[34:37], v0, s[40:43], s95 offen sc1
    v_mfma_f32_16x16x32_bf16 v[66:69], a[68:71], v[38:41], v[66:69]
    ds_write_b128 v1, v[58:61] offset:3264
    v_mfma_f32_16x16x32_bf16 v[70:73], a[72:75], v[38:41], v[70:73]
    s_waitcnt vmcnt(7)
    v_cmp_ne_u32 vcc, s26, v127
    s_add_u32 s74, s76, 256000
    v_mfma_f32_16x16x32_bf16 v[74:77], a[76:79], v[38:41], v[74:77]
    v_mfma_f32_16x16x32_bf16 v[62:65], a[80:83], v[42:45], v[62:65]
    s_and_b32 s4, vcc_lo, 0x3fff
    s_cbranch_scc0 Lgk2
Lgf2:
    s_add_u32 s74, s74, 64
    s_and_b32 s4, s74, 255
    s_cbranch_scc0 Lgv2
    s_load_dwordx16 s[8:23], s[56:57], s74
Lg2:
    s_waitcnt lgkmcnt(0)
    s_xor_b64 s[8:9], s[8:9], s[26:27]
    s_xor_b64 s[10:11], s[10:11], s[26:27]
    s_or_b64 s[8:9], s[8:9], s[10:11]
    s_xor_b64 s[12:13], s[12:13], s[26:27]
    s_or_b64 s[8:9], s[8:9], s[12:13]
    s_xor_b64 s[14:15], s[14:15], s[26:27]
    s_or_b64 s[8:9], s[8:9], s[14:15]
    s_xor_b64 s[16:17], s[16:17], s[26:27]
    s_or_b64 s[8:9], s[8:9], s[16:17]
    s_xor_b64 s[18:19], s[18:19], s[26:27]
    s_or_b64 s[8:9], s[8:9], s[18:19]
    s_xor_b64 s[20:21], s[20:21], s[26:27]
    s_or_b64 s[8:9], s[8:9], s[20:21]
    s_cbranch_scc1 Lgf2
Lgk2:
    s_add_u32 s40, s40, 57344
    s_addc_u32 s41, s41, 0
    buffer_load_dwordx4 v[38:41], v0, s[40:43], s82 offen sc1
    v_mfma_f32_16x16x32_bf16 v[66:69], a[84:87], v[42:45], v[66:69]
    ds_read_b128 v[46:49], v0 offset:34816
    v_mfma_f32_16x16x32_bf16 v[70:73], a[88:91], v[42:45], v[70:73]
    ds_read_b128 v[50:53], v0 offset:35840
    ds_read_b128 v[54:57], v0 offset:36864
    v_mfma_f32_16x16x32_bf16 v[74:77], a[92:95], v[42:45], v[74:77]
    ds_read_b128 v[58:61], v0 offset:37888
    v_mfma_f32_16x16x32_bf16 v[62:65], a[96:99], v[6:9], v[62:65]
    buffer_load_dwordx4 v[42:45], v0, s[40:43], s83 offen sc1
    v_mfma_f32_16x16x32_bf16 v[66:69], a[100:103], v[6:9], v[66:69]
    v_mfma_f32_16x16x32_bf16 v[70:73], a[104:107], v[6:9], v[70:73]
    v_mfma_f32_16x16x32_bf16 v[74:77], a[108:111], v[6:9], v[74:77]
    s_waitcnt vmcnt(8) lgkmcnt(0)
    v_mfma_f32_16x16x32_bf16 v[62:65], v[46:49], v[10:13], v[62:65]
    buffer_load_dwordx4 v[6:9], v0, s[40:43], s84 offen sc1
    v_mfma_f32_16x16x32_bf16 v[66:69], v[50:53], v[10:13], v[66:69]
    v_mfma_f32_16x16x32_bf16 v[70:73], v[54:57], v[10:13], v[70:73]
    v_mfma_f32_16x16x32_bf16 v[74:77], v[58:61], v[10:13], v[74:77]
    s_waitcnt vmcnt(8)
    v_mfma_f32_16x16x32_bf16 v[62:65], a[112:115], v[14:17], v[62:65]
    buffer_load_dwordx4 v[10:13], v0, s[40:43], s85 offen sc1
    v_mfma_f32_16x16x32_bf16 v[66:69], a[116:119], v[14:17], v[66:69]
    ds_read_b64_tr_b16 v[46:47], v2 offset:8192
    ds_read_b64_tr_b16 v[48:49], v2 offset:0
    ds_read_b64_tr_b16 v[50:51], v3 offset:8192
    v_mfma_f32_16x16x32_bf16 v[70:73], a[120:123], v[14:17], v[70:73]
    ds_read_b64_tr_b16 v[52:53], v3 offset:0
    ds_read_b64_tr_b16 v[54:55], v4 offset:8192
    ds_read_b64_tr_b16 v[56:57], v4 offset:0
    v_mfma_f32_16x16x32_bf16 v[74:77], a[124:127], v[14:17], v[74:77]
    ds_read_b64_tr_b16 v[58:59], v5 offset:8192
    ds_read_b64_tr_b16 v[60:61], v5 offset:0
    s_waitcnt vmcnt(8)
    v_mfma_f32_16x16x32_bf16 v[62:65], v[78:81], v[18:21], v[62:65]
    buffer_load_dwordx4 v[14:17], v0, s[40:43], s86 offen sc1
    v_mfma_f32_16x16x32_bf16 v[66:69], v[82:85], v[18:21], v[66:69]
    v_mfma_f32_16x16x32_bf16 v[70:73], v[86:89], v[18:21], v[70:73]
    v_mfma_f32_16x16x32_bf16 v[74:77], v[90:93], v[18:21], v[74:77]
    s_waitcnt vmcnt(8) lgkmcnt(0)
    v_mfma_f32_16x16x32_bf16 v[62:65], v[46:49], v[22:25], v[62:65]
    buffer_load_dwordx4 v[18:21], v0, s[40:43], s87 offen sc1
    v_mfma_f32_16x16x32_bf16 v[66:69], v[50:53], v[22:25], v[66:69]
    v_mfma_f32_16x16x32_bf16 v[70:73], v[54:57], v[22:25], v[70:73]
    v_mfma_f32_16x16x32_bf16 v[74:77], v[58:61], v[22:25], v[74:77]
    s_waitcnt vmcnt(8)
    v_mfma_f32_16x16x32_bf16 v[62:65], v[94:97], v[26:29], v[62:65]
    buffer_load_dwordx4 v[22:25], v0, s[40:43], s88 offen sc1
    v_mfma_f32_16x16x32_bf16 v[66:69], v[98:101], v[26:29], v[66:69]
    s_mov_b64 exec, 0x3fff
    buffer_load_dword v127, v0, s[44:47], 0 offen offset:3072 sc1
    s_mov_b64 exec, -1
    ds_read_b64_tr_b16 v[46:47], v2 offset:2048
    ds_read_b64_tr_b16 v[48:49], v2 offset:4096
    ds_read_b64_tr_b16 v[50:51], v3 offset:2048
    v_mfma_f32_16x16x32_bf16 v[70:73], v[102:105], v[26:29], v[70:73]
    ds_read_b64_tr_b16 v[52:53], v3 offset:4096
    ds_read_b64_tr_b16 v[54:55], v4 offset:2048
    ds_read_b64_tr_b16 v[56:57], v4 offset:4096
    v_mfma_f32_16x16x32_bf16 v[74:77], v[106:109], v[26:29], v[74:77]
    ds_read_b64_tr_b16 v[58:59], v5 offset:2048
    ds_read_b64_tr_b16 v[60:61], v5 offset:4096
    s_waitcnt vmcnt(9)
    v_mfma_f32_16x16x32_bf16 v[62:65], v[110:113], v[30:33], v[62:65]
    buffer_load_dwordx4 v[26:29], v0, s[40:43], s93 offen sc1
    v_mfma_f32_16x16x32_bf16 v[66:69], v[114:117], v[30:33], v[66:69]
    v_mfma_f32_16x16x32_bf16 v[70:73], v[118:121], v[30:33], v[70:73]
    v_mfma_f32_16x16x32_bf16 v[74:77], v[122:125], v[30:33], v[74:77]
    s_waitcnt vmcnt(9) lgkmcnt(0)
    v_mfma_f32_16x16x32_bf16 v[62:65], v[46:49], v[34:37], v[62:65]
    buffer_load_dwordx4 v[30:33], v0, s[40:43], s89 offen sc1
    v_mfma_f32_16x16x32_bf16 v[66:69], v[50:53], v[34:37], v[66:69]
    v_mfma_f32_16x16x32_bf16 v[70:73], v[54:57], v[34:37], v[70:73]
    v_mfma_f32_16x16x32_bf16 v[74:77], v[58:61], v[34:37], v[74:77]
    s_waitcnt vmcnt(9)
    v_mfma_f32_16x16x32_bf16 v[46:49], a[0:3], v[38:41], 0
    buffer_load_dwordx4 v[34:37], v0, s[40:43], s90 offen sc1
    v_mfma_f32_16x16x32_bf16 v[50:53], a[4:7], v[38:41], 0
    v_mfma_f32_16x16x32_bf16 v[54:57], a[8:11], v[38:41], 0
    ds_write_b128 v1, v[62:65] offset:17408
    v_mfma_f32_16x16x32_bf16 v[58:61], a[12:15], v[38:41], 0
    s_waitcnt vmcnt(9)
    v_mfma_f32_16x16x32_bf16 v[46:49], a[16:19], v[42:45], v[46:49]
    buffer_load_dwordx4 v[38:41], v0, s[40:43], s94 offen sc1
    v_mfma_f32_16x16x32_bf16 v[50:53], a[20:23], v[42:45], v[50:53]
    v_mfma_f32_16x16x32_bf16 v[54:57], a[24:27], v[42:45], v[54:57]
    v_mfma_f32_16x16x32_bf16 v[58:61], a[28:31], v[42:45], v[58:61]
    s_waitcnt vmcnt(9)
    v_mfma_f32_16x16x32_bf16 v[46:49], a[32:35], v[6:9], v[46:49]
    buffer_load_dwordx4 v[42:45], v0, s[40:43], s91 offen sc1
    v_mfma_f32_16x16x32_bf16 v[50:53], a[36:39], v[6:9], v[50:53]
    ds_write_b128 v1, v[66:69] offset:18496
    s_branch Lsk2
Lstub2:
    s_setpc_b64 s[28:29]
Lsk2:
    v_mfma_f32_16x16x32_bf16 v[54:57], a[40:43], v[6:9], v[54:57]
    v_mfma_f32_16x16x32_bf16 v[58:61], a[44:47], v[6:9], v[58:61]
    s_waitcnt vmcnt(9)
    v_mfma_f32_16x16x32_bf16 v[46:49], a[48:51], v[10:13], v[46:49]
    buffer_load_dwordx4 v[6:9], v0, s[40:43], s92 offen sc1
    v_mfma_f32_16x16x32_bf16 v[50:53], a[52:55], v[10:13], v[50:53]
    ds_write_b128 v1, v[70:73] offset:19584
    v_mfma_f32_16x16x32_bf16 v[54:57], a[56:59], v[10:13], v[54:57]
    v_mfma_f32_16x16x32_bf16 v[58:61], a[60:63], v[10:13], v[58:61]
    s_waitcnt vmcnt(9)
    v_mfma_f32_16x16x32_bf16 v[46:49], a[64:67], v[14:17], v[46:49]
    buffer_load_dwordx4 v[10:13], v0, s[40:43], s95 offen sc1
    v_mfma_f32_16x16x32_bf16 v[50:53], a[68:71], v[14:17], v[50:53]
    ds_write_b128 v1, v[74:77] offset:20672
    v_mfma_f32_16x16x32_bf16 v[54:57], a[72:75], v[14:17], v[54:57]
    s_waitcnt vmcnt(7)
    v_cmp_ne_u32 vcc, s26, v127
    s_add_u32 s74, s76, 257024
    v_mfma_f32_16x16x32_bf16 v[58:61], a[76:79], v[14:17], v[58:61]
    v_mfma_f32_16x16x32_bf16 v[46:49], a[80:83], v[18:21], v[46:49]
    s_and_b32 s4, vcc_lo, 0x3fff
    s_cbranch_scc0 Lgk3
Lgf3:
    s_add_u32 s74, s74, 64
    s_and_b32 s4, s74, 255
    s_cbranch_scc0 Lgv3
    s_load_dwordx16 s[8:23], s[56:57], s74
Lg3:
    s_waitcnt lgkmcnt(0)
    s_xor_b64 s[8:9], s[8:9], s[26:27]
    s_xor_b64 s[10:11], s[10:11], s[26:27]
    s_or_b64 s[8:9], s[8:9], s[10:11]
    s_xor_b64 s[12:13], s[12:13], s[26:27]
    s_or_b64 s[8:9], s[8:9], s[12:13]
    s_xor_b64 s[14:15], s[14:15], s[26:27]
    s_or_b64 s[8:9], s[8:9], s[14:15]
    s_xor_b64 s[16:17], s[16:17], s[26:27]
    s_or_b64 s[8:9], s[8:9], s[16:17]
    s_xor_b64 s[18:19], s[18:19], s[26:27]
    s_or_b64 s[8:9], s[8:9], s[18:19]
    s_xor_b64 s[20:21], s[20:21], s[26:27]
    s_or_b64 s[8:9], s[8:9], s[20:21]
    s_cbranch_scc1 Lgf3
Lgk3:
    s_add_u32 s40, s40, 57344
    s_addc_u32 s41, s41, 0
    buffer_load_dwordx4 v[14:17], v0, s[40:43], s82 offen sc1
    v_mfma_f32_16x16x32_bf16 v[50:53], a[84:87], v[18:21], v[50:53]
    ds_read_b128 v[62:65], v0 offset:34816
    v_mfma_f32_16x16x32_bf16 v[54:57], a[88:91], v[18:21], v[54:57]
    ds_read_b128 v[66:69], v0 offset:35840
    ds_read_b128 v[70:73], v0 offset:36864
    v_mfma_f32_16x16x32_bf16 v[58:61], a[92:95], v[18:21], v[58:61]
    ds_read_b128 v[74:77], v0 offset:37888
    v_mfma_f32_16x16x32_bf16 v[46:49], a[96:99], v[22:25], v[46:49]
    buffer_load_dwordx4 v[18:21], v0, s[40:43], s83 offen sc1
    v_mfma_f32_16x16x32_bf16 v[50:53], a[100:103], v[22:25], v[50:53]
    v_mfma_f32_16x16x32_bf16 v[54:57], a[104:107], v[22:25], v[54:57]
    v_mfma_f32_16x16x32_bf16 v[58:61], a[108:111], v[22:25], v[58:61]
    s_barrier
    s_waitcnt vmcnt(8) lgkmcnt(0)
    v_mfma_f32_16x16x32_bf16 v[46:49], v[62:65], v[26:29], v[46:49]
    buffer_load_dwordx4 v[22:25], v0, s[40:43], s84 offen sc1
    v_mfma_f32_16x16x32_bf16 v[50:53], v[66:69], v[26:29], v[50:53]
    v_mfma_f32_16x16x32_bf16 v[54:57], v[70:73], v[26:29], v[54:57]
    v_mfma_f32_16x16x32_bf16 v[58:61], v[74:77], v[26:29], v[58:61]
    s_waitcnt vmcnt(8)
    v_mfma_f32_16x16x32_bf16 v[46:49], a[112:115], v[30:33], v[46:49]
    buffer_load_dwordx4 v[26:29], v0, s[40:43], s85 offen sc1
    v_mfma_f32_16x16x32_bf16 v[50:53], a[116:119], v[30:33], v[50:53]
    ds_read_b64_tr_b16 v[62:63], v2 offset:8192
    ds_read_b64_tr_b16 v[64:65], v2 offset:0
    ds_read_b64_tr_b16 v[66:67], v3 offset:8192
    v_mfma_f32_16x16x32_bf16 v[54:57], a[120:123], v[30:33], v[54:57]
    ds_read_b64_tr_b16 v[68:69], v3 offset:0
    ds_read_b64_tr_b16 v[70:71], v4 offset:8192
    ds_read_b64_tr_b16 v[72:73], v4 offset:0
    v_mfma_f32_16x16x32_bf16 v[58:61], a[124:127], v[30:33], v[58:61]
    ds_read_b64_tr_b16 v[74:75], v5 offset:8192
    ds_read_b64_tr_b16 v[76:77], v5 offset:0
    s_waitcnt vmcnt(8)
    v_mfma_f32_16x16x32_bf16 v[46:49], v[78:81], v[34:37], v[46:49]
    buffer_load_dwordx4 v[30:33], v0, s[40:43], s86 offen sc1
    v_mfma_f32_16x16x32_bf16 v[50:53], v[82:85], v[34:37], v[50:53]
    v_mfma_f32_16x16x32_bf16 v[54:57], v[86:89], v[34:37], v[54:57]
    v_mfma_f32_16x16x32_bf16 v[58:61], v[90:93], v[34:37], v[58:61]
    s_waitcnt vmcnt(8) lgkmcnt(0)
    v_mfma_f32_16x16x32_bf16 v[46:49], v[62:65], v[38:41], v[46:49]
    buffer_load_dwordx4 v[34:37], v0, s[40:43], s87 offen sc1
    v_mfma_f32_16x16x32_bf16 v[50:53], v[66:69], v[38:41], v[50:53]
    v_mfma_f32_16x16x32_bf16 v[54:57], v[70:73], v[38:41], v[54:57]
    v_mfma_f32_16x16x32_bf16 v[58:61], v[74:77], v[38:41], v[58:61]
    s_waitcnt vmcnt(8)
    v_mfma_f32_16x16x32_bf16 v[46:49], v[94:97], v[42:45], v[46:49]
    buffer_load_dwordx4 v[38:41], v0, s[40:43], s88 offen sc1
    v_mfma_f32_16x16x32_bf16 v[50:53], v[98:101], v[42:45], v[50:53]
    ds_read_b64_tr_b16 v[62:63], v2 offset:2048
    ds_read_b64_tr_b16 v[64:65], v2 offset:4096
    ds_read_b64_tr_b16 v[66:67], v3 offset:2048
    v_mfma_f32_16x16x32_bf16 v[54:57], v[102:105], v[42:45], v[54:57]
    ds_read_b64_tr_b16 v[68:69], v3 offset:4096
    ds_read_b64_tr_b16 v[70:71], v4 offset:2048
    ds_read_b64_tr_b16 v[72:73], v4 offset:4096
    v_mfma_f32_16x16x32_bf16 v[58:61], v[106:109], v[42:45], v[58:61]
    ds_read_b64_tr_b16 v[74:75], v5 offset:2048
    ds_read_b64_tr_b16 v[76:77], v5 offset:4096
    s_waitcnt vmcnt(8)
    v_mfma_f32_16x16x32_bf16 v[46:49], v[110:113], v[6:9], v[46:49]
    buffer_load_dwordx4 v[42:45], v0, s[40:43], s93 offen sc1
    v_mfma_f32_16x16x32_bf16 v[50:53], v[114:117], v[6:9], v[50:53]
    v_mfma_f32_16x16x32_bf16 v[54:57], v[118:121], v[6:9], v[54:57]
    v_mfma_f32_16x16x32_bf16 v[58:61], v[122:125], v[6:9], v[58:61]
    s_waitcnt vmcnt(8) lgkmcnt(0)
    v_mfma_f32_16x16x32_bf16 v[46:49], v[62:65], v[10:13], v[46:49]
    buffer_load_dwordx4 v[6:9], v0, s[40:43], s89 offen sc1
    v_mfma_f32_16x16x32_bf16 v[50:53], v[66:69], v[10:13], v[50:53]
    v_mfma_f32_16x16x32_bf16 v[54:57], v[70:73], v[10:13], v[54:57]
    v_mfma_f32_16x16x32_bf16 v[58:61], v[74:77], v[10:13], v[58:61]
    s_waitcnt vmcnt(8)
    v_mfma_f32_16x16x32_bf16 v[62:65], a[0:3], v[14:17], 0
    buffer_load_dwordx4 v[10:13], v0, s[40:43], s90 offen sc1
    v_mfma_f32_16x16x32_bf16 v[66:69], a[4:7], v[14:17], 0
    v_mfma_f32_16x16x32_bf16 v[70:73], a[8:11], v[14:17], 0
    ds_write_b128 v1, v[46:49] offset:51200
    v_mfma_f32_16x16x32_bf16 v[74:77], a[12:15], v[14:17], 0
    s_waitcnt vmcnt(8)
    v_mfma_f32_16x16x32_bf16 v[62:65], a[16:19], v[18:21], v[62:65]
    buffer_load_dwordx4 v[14:17], v0, s[40:43], s94 offen sc1
    v_mfma_f32_16x16x32_bf16 v[66:69], a[20:23], v[18:21], v[66:69]
    v_mfma_f32_16x16x32_bf16 v[70:73], a[24:27], v[18:21], v[70:73]
    v_mfma_f32_16x16x32_bf16 v[74:77], a[28:31], v[18:21], v[74:77]
    s_waitcnt vmcnt(8)
    v_mfma_f32_16x16x32_bf16 v[62:65], a[32:35], v[22:25], v[62:65]
    buffer_load_dwordx4 v[18:21], v0, s[40:43], s91 offen sc1
    v_mfma_f32_16x16x32_bf16 v[66:69], a[36:39], v[22:25], v[66:69]
    ds_write_b128 v1, v[50:53] offset:52288
    v_mfma_f32_16x16x32_bf16 v[70:73], a[40:43], v[22:25], v[70:73]
    v_mfma_f32_16x16x32_bf16 v[74:77], a[44:47], v[22:25], v[74:77]
    s_waitcnt vmcnt(8)
    v_mfma_f32_16x16x32_bf16 v[62:65], a[48:51], v[26:29], v[62:65]
    buffer_load_dwordx4 v[22:25], v0, s[40:43], s92 offen sc1
    v_mfma_f32_16x16x32_bf16 v[66:69], a[52:55], v[26:29], v[66:69]
    ds_write_b128 v1, v[54:57] offset:53376
    v_mfma_f32_16x16x32_bf16 v[70:73], a[56:59], v[26:29], v[70:73]
    v_mfma_f32_16x16x32_bf16 v[74:77], a[60:63], v[26:29], v[74:77]
    s_waitcnt vmcnt(8)
    v_mfma_f32_16x16x32_bf16 v[62:65], a[64:67], v[30:33], v[62:65]
    buffer_load_dwordx4 v[26:29], v0, s[40:43], s95 offen sc1
    v_mfma_f32_16x16x32_bf16 v[66:69], a[68:71], v[30:33], v[66:69]
    ds_write_b128 v1, v[58:61] offset:54464
    v_mfma_f32_16x16x32_bf16 v[70:73], a[72:75], v[30:33], v[70:73]
    v_mfma_f32_16x16x32_bf16 v[74:77], a[76:79], v[30:33], v[74:77]
    s_waitcnt vmcnt(8)
    v_mfma_f32_16x16x32_bf16 v[62:65], a[80:83], v[34:37], v[62:65]
    v_mfma_f32_16x16x32_bf16 v[66:69], a[84:87], v[34:37], v[66:69]
    ds_read_b128 v[46:49], v0 offset:34816
    v_mfma_f32_16x16x32_bf16 v[70:73], a[88:91], v[34:37], v[70:73]
    ds_read_b128 v[50:53], v0 offset:35840
    ds_read_b128 v[54:57], v0 offset:36864
    v_mfma_f32_16x16x32_bf16 v[74:77], a[92:95], v[34:37], v[74:77]
    ds_read_b128 v[58:61], v0 offset:37888
    s_waitcnt lgkmcnt(4)
    s_barrier
    s_waitcnt vmcnt(7)
    v_mfma_f32_16x16x32_bf16 v[62:65], a[96:99], v[38:41], v[62:65]
    v_mfma_f32_16x16x32_bf16 v[66:69], a[100:103], v[38:41], v[66:69]
    v_mfma_f32_16x16x32_bf16 v[70:73], a[104:107], v[38:41], v[70:73]
    v_mfma_f32_16x16x32_bf16 v[74:77], a[108:111], v[38:41], v[74:77]
    s_waitcnt vmcnt(6) lgkmcnt(0)
    v_mfma_f32_16x16x32_bf16 v[62:65], v[46:49], v[42:45], v[62:65]
    v_mfma_f32_16x16x32_bf16 v[66:69], v[50:53], v[42:45], v[66:69]
    v_mfma_f32_16x16x32_bf16 v[70:73], v[54:57], v[42:45], v[70:73]
    v_mfma_f32_16x16x32_bf16 v[74:77], v[58:61], v[42:45], v[74:77]
    s_waitcnt vmcnt(5)
    v_mfma_f32_16x16x32_bf16 v[62:65], a[112:115], v[6:9], v[62:65]
    v_mfma_f32_16x16x32_bf16 v[66:69], a[116:119], v[6:9], v[66:69]
    ds_read_b64_tr_b16 v[46:47], v2 offset:8192
    ds_read_b64_tr_b16 v[48:49], v2 offset:0
    ds_read_b64_tr_b16 v[50:51], v3 offset:8192
    v_mfma_f32_16x16x32_bf16 v[70:73], a[120:123], v[6:9], v[70:73]
    ds_read_b64_tr_b16 v[52:53], v3 offset:0
    ds_read_b64_tr_b16 v[54:55], v4 offset:8192
    ds_read_b64_tr_b16 v[56:57], v4 offset:0
    v_mfma_f32_16x16x32_bf16 v[74:77], a[124:127], v[6:9], v[74:77]
    ds_read_b64_tr_b16 v[58:59], v5 offset:8192
    ds_read_b64_tr_b16 v[60:61], v5 offset:0
    s_waitcnt vmcnt(4)
    v_mfma_f32_16x16x32_bf16 v[62:65], v[78:81], v[10:13], v[62:65]
    ds_read_b64_tr_b16 v[30:31], v2 offset:2048
    ds_read_b64_tr_b16 v[32:33], v2 offset:4096
    v_mfma_f32_16x16x32_bf16 v[66:69], v[82:85], v[10:13], v[66:69]
    ds_read_b64_tr_b16 v[34:35], v3 offset:2048
    ds_read_b64_tr_b16 v[36:37], v3 offset:4096
    v_mfma_f32_16x16x32_bf16 v[70:73], v[86:89], v[10:13], v[70:73]
    ds_read_b64_tr_b16 v[38:39], v4 offset:2048
    ds_read_b64_tr_b16 v[40:41], v4 offset:4096
    v_mfma_f32_16x16x32_bf16 v[74:77], v[90:93], v[10:13], v[74:77]
    ds_read_b64_tr_b16 v[42:43], v5 offset:2048
    ds_read_b64_tr_b16 v[44:45], v5 offset:4096
    s_waitcnt vmcnt(2)
    v_mfma_f32_16x16x32_bf16 v[62:65], v[94:97], v[18:21], v[62:65]
    s_waitcnt vmcnt(1)
    v_mfma_f32_16x16x32_bf16 v[62:65], v[110:113], v[22:25], v[62:65]
    s_waitcnt lgkmcnt(8)
    v_mfma_f32_16x16x32_bf16 v[62:65], v[46:49], v[14:17], v[62:65]
    s_waitcnt vmcnt(0) lgkmcnt(0)
    v_mfma_f32_16x16x32_bf16 v[62:65], v[30:33], v[26:29], v[62:65]
    v_mfma_f32_16x16x32_bf16 v[66:69], v[98:101], v[18:21], v[66:69]
    v_mfma_f32_16x16x32_bf16 v[66:69], v[114:117], v[22:25], v[66:69]
    v_mfma_f32_16x16x32_bf16 v[66:69], v[50:53], v[14:17], v[66:69]
    v_mfma_f32_16x16x32_bf16 v[66:69], v[34:37], v[26:29], v[66:69]
    s_nop 3
    ds_write_b128 v1, v[62:65] offset:0
    v_mfma_f32_16x16x32_bf16 v[70:73], v[102:105], v[18:21], v[70:73]
    v_mfma_f32_16x16x32_bf16 v[70:73], v[118:121], v[22:25], v[70:73]
    v_mfma_f32_16x16x32_bf16 v[70:73], v[54:57], v[14:17], v[70:73]
    v_mfma_f32_16x16x32_bf16 v[70:73], v[38:41], v[26:29], v[70:73]
    ds_write_b128 v1, v[66:69] offset:1088
    v_mfma_f32_16x16x32_bf16 v[74:77], v[106:109], v[18:21], v[74:77]
    v_mfma_f32_16x16x32_bf16 v[74:77], v[122:125], v[22:25], v[74:77]
    v_mfma_f32_16x16x32_bf16 v[74:77], v[58:61], v[14:17], v[74:77]
    v_mfma_f32_16x16x32_bf16 v[74:77], v[42:45], v[26:29], v[74:77]
    s_nop 2
    ds_write_b128 v1, v[70:73] offset:2176
    s_nop 3
    ds_write_b128 v1, v[74:77] offset:3264
    s_waitcnt lgkmcnt(0)
    s_barrier
    s_branch Lfin
LA2:
    s_barrier
    ds_read_b64_tr_b16 a[20:21], v98 offset:8192
    ds_read_b64_tr_b16 a[22:23], v98 offset:9216
    ds_read_b64_tr_b16 a[24:25], v98 offset:12288
    ds_read_b64_tr_b16 a[26:27], v98 offset:13312
    ds_read_b128 a[0:3], v96 offset:0
    ds_read_b128 a[4:7], v96 offset:2048
    ds_read_b128 a[8:11], v96 offset:4096
    ds_read_b128 a[12:15], v96 offset:6144
    ds_read_b128 a[16:19], v96 offset:8192
    ds_read_b64_tr_b16 a[48:49], v98 offset:16384
    ds_read_b64_tr_b16 a[50:51], v98 offset:17408
    ds_read_b64_tr_b16 a[52:53], v98 offset:20480
    ds_read_b64_tr_b16 a[54:55], v98 offset:21504
    ds_read_b128 a[28:31], v97 offset:0
    ds_read_b128 a[32:35], v97 offset:2048
    ds_read_b128 a[36:39], v97 offset:4096
    ds_read_b128 a[40:43], v97 offset:6144
    ds_read_b128 a[44:47], v97 offset:8192
    s_waitcnt lgkmcnt(9)
    v_mfma_f32_16x16x32_bf16 v[16:19], a[20:23], a[0:3], 0
    v_lshlrev_b32 v102, 2, v9
    v_mfma_f32_16x16x32_bf16 v[20:23], a[20:23], a[4:7], 0
    v_add_u32 v102, 71680, v102
    v_mfma_f32_16x16x32_bf16 v[24:27], a[20:23], a[8:11], 0
    s_lshl_b32 s4, s67, 7
    v_mfma_f32_16x16x32_bf16 v[28:31], a[20:23], a[12:15], 0
    s_add_u32 s4, s4, 71680
    v_mfma_f32_16x16x32_bf16 v[32:35], a[20:23], a[16:19], 0
    v_lshl_add_u32 v116, v10, 4, s4
    v_mfma_f32_16x16x32_bf16 v[36:39], a[24:27], a[0:3], 0
    v_mov_b32 v6, 2147483632
    v_mfma_f32_16x16x32_bf16 v[40:43], a[24:27], a[4:7], 0
    v_lshlrev_b32 v5, 6, v0
    v_mfma_f32_16x16x32_bf16 v[44:47], a[24:27], a[8:11], 0
    v_cmp_gt_u32 vcc, 8, v0
    v_mfma_f32_16x16x32_bf16 v[48:51], a[24:27], a[12:15], 0
    v_mfma_f32_16x16x32_bf16 v[52:55], a[24:27], a[16:19], 0
    s_waitcnt lgkmcnt(0)
    v_mfma_f32_16x16x32_bf16 v[16:19], a[48:51], a[28:31], v[16:19]
    v_cndmask_b32 v124, v6, v5, vcc
    v_mfma_f32_16x16x32_bf16 v[20:23], a[48:51], a[32:35], v[20:23]
    v_lshlrev_b32 v5, 7, v0
    v_mfma_f32_16x16x32_bf16 v[24:27], a[48:51], a[36:39], v[24:27]
    v_cndmask_b32 v11, v6, v5, vcc
    v_mfma_f32_16x16x32_bf16 v[28:31], a[48:51], a[40:43], v[28:31]
    v_cmp_gt_u32 vcc, 48, v0
    v_mfma_f32_16x16x32_bf16 v[32:35], a[48:51], a[44:47], v[32:35]
    s_nop 0
    v_cndmask_b32 v12, v6, v14, vcc
    v_mfma_f32_16x16x32_bf16 v[36:39], a[52:55], a[28:31], v[36:39]
    s_mov_b32 s43, 720896
    v_mfma_f32_16x16x32_bf16 v[40:43], a[52:55], a[32:35], v[40:43]
    v_min_u32 v125, 13, v9
    v_mfma_f32_16x16x32_bf16 v[44:47], a[52:55], a[36:39], v[44:47]
    v_lshlrev_b32 v125, 2, v125
    v_mfma_f32_16x16x32_bf16 v[48:51], a[52:55], a[40:43], v[48:51]
    v_mfma_f32_16x16x32_bf16 v[52:55], a[52:55], a[44:47], v[52:55]
    s_barrier
    ds_read_b64_tr_b16 a[76:77], v99 offset:16384
    ds_read_b64_tr_b16 a[78:79], v99 offset:17408
    ds_read_b64_tr_b16 a[80:81], v99 offset:20480
    ds_read_b64_tr_b16 a[82:83], v99 offset:21504
    ds_read_b128 a[56:59], v96 offset:10240
    ds_read_b128 a[60:63], v96 offset:12288
    ds_read_b128 a[64:67], v96 offset:14336
    ds_read_b128 a[68:71], v96 offset:16384
    ds_read_b128 a[72:75], v96 offset:18432
    ds_read_b64_tr_b16 a[104:105], v99 offset:24576
    ds_read_b64_tr_b16 a[106:107], v99 offset:25600
    ds_read_b64_tr_b16 a[108:109], v99 offset:28672
    ds_read_b64_tr_b16 a[110:111], v99 offset:29696
    ds_read_b128 a[84:87], v97 offset:10240
    ds_read_b128 a[88:91], v97 offset:12288
    ds_read_b128 a[92:95], v97 offset:14336
    ds_read_b128 a[96:99], v97 offset:16384
    ds_read_b128 a[100:103], v97 offset:18432
    s_waitcnt lgkmcnt(9)
    s_barrier
    v_mfma_f32_16x16x32_bf16 v[16:19], a[76:79], a[56:59], v[16:19]
    ds_read_b64_tr_b16 a[20:21], v99 offset:0
    s_lshl_b32 s4, s62, 2
    v_mfma_f32_16x16x32_bf16 v[20:23], a[76:79], a[60:63], v[20:23]
    ds_read_b64_tr_b16 a[22:23], v99 offset:1024
    s_add_u32 s4, s4, s60
    v_mfma_f32_16x16x32_bf16 v[24:27], a[76:79], a[64:67], v[24:27]
    ds_read_b64_tr_b16 a[24:25], v99 offset:4096
    s_mul_i32 s5, s61, 143360
    v_mfma_f32_16x16x32_bf16 v[28:31], a[76:79], a[68:71], v[28:31]
    ds_read_b64_tr_b16 a[26:27], v99 offset:5120
    s_add_u32 s78, s5, 1048576
    v_mfma_f32_16x16x32_bf16 v[32:35], a[76:79], a[72:75], v[32:35]
    ds_read_b128 a[0:3], v96 offset:20480
    s_lshl_b32 s5, s4, 10
    v_mfma_f32_16x16x32_bf16 v[36:39], a[80:83], a[56:59], v[36:39]
    ds_read_b128 a[4:7], v96 offset:22528
    s_add_u32 s77, s78, s5
    v_mfma_f32_16x16x32_bf16 v[40:43], a[80:83], a[60:63], v[40:43]
    ds_read_b128 a[8:11], v96 offset:24576
    s_lshl_b32 s4, s4, 2
    v_mfma_f32_16x16x32_bf16 v[44:47], a[80:83], a[64:67], v[44:47]
    ds_read_b128 a[12:15], v96 offset:26624
    s_lshl_b32 s5, s61, 10
    v_mfma_f32_16x16x32_bf16 v[48:51], a[80:83], a[68:71], v[48:51]
    ds_read_b128 a[16:19], v96 offset:28672
    s_add_u32 s74, s5, 724992
    v_mfma_f32_16x16x32_bf16 v[52:55], a[80:83], a[72:75], v[52:55]
    ds_read_b64_tr_b16 a[48:49], v99 offset:8192
    s_add_u32 s4, s4, s74
    s_waitcnt lgkmcnt(10)
    v_mfma_f32_16x16x32_bf16 v[16:19], a[104:107], a[84:87], v[16:19]
    ds_read_b64_tr_b16 a[50:51], v99 offset:9216
    v_add_u32 v11, s4, v11
    v_mfma_f32_16x16x32_bf16 v[20:23], a[104:107], a[88:91], v[20:23]
    ds_read_b64_tr_b16 a[52:53], v99 offset:12288
    s_lshl_b32 s76, s62, 1
    v_mfma_f32_16x16x32_bf16 v[24:27], a[104:107], a[92:95], v[24:27]
    ds_read_b64_tr_b16 a[54:55], v99 offset:13312
    s_add_u32 s76, s76, s66
    v_mfma_f32_16x16x32_bf16 v[28:31], a[104:107], a[96:99], v[28:31]
    ds_read_b128 a[28:31], v97 offset:20480
    v_mfma_f32_16x16x32_bf16 v[32:35], a[104:107], a[100:103], v[32:35]
    ds_read_b128 a[32:35], v97 offset:22528
    v_mfma_f32_16x16x32_bf16 v[36:39], a[108:111], a[84:87], v[36:39]
    ds_read_b128 a[36:39], v97 offset:24576
    v_mfma_f32_16x16x32_bf16 v[40:43], a[108:111], a[88:91], v[40:43]
    ds_read_b128 a[40:43], v97 offset:26624
    v_mfma_f32_16x16x32_bf16 v[44:47], a[108:111], a[92:95], v[44:47]
    ds_read_b128 a[44:47], v97 offset:28672
    v_mfma_f32_16x16x32_bf16 v[48:51], a[108:111], a[96:99], v[48:51]
    v_mfma_f32_16x16x32_bf16 v[52:55], a[108:111], a[100:103], v[52:55]
    s_waitcnt lgkmcnt(9)
    s_barrier
    v_mfma_f32_16x16x32_bf16 v[16:19], a[20:23], a[0:3], v[16:19]
    ds_read_b64_tr_b16 a[76:77], v98 offset:40960
    s_cmp_ge_u32 s76, 7
    v_mfma_f32_16x16x32_bf16 v[20:23], a[20:23], a[4:7], v[20:23]
    ds_read_b64_tr_b16 a[78:79], v98 offset:41984
    s_cselect_b32 s6, 14, 7
    v_mfma_f32_16x16x32_bf16 v[24:27], a[20:23], a[8:11], v[24:27]
    ds_read_b64_tr_b16 a[80:81], v98 offset:45056
    s_addc_u32 s4, s76, 0
    v_mfma_f32_16x16x32_bf16 v[28:31], a[20:23], a[12:15], v[28:31]
    ds_read_b64_tr_b16 a[82:83], v98 offset:46080
    s_sub_u32 s6, s6, s76
    v_mfma_f32_16x16x32_bf16 v[32:35], a[20:23], a[16:19], v[32:35]
    ds_read_b128 a[56:59], v96 offset:30720
    v_cmp_gt_u32 s[82:83], s6, v122
    v_mfma_f32_16x16x32_bf16 v[36:39], a[24:27], a[0:3], v[36:39]
    ds_read_b128 a[60:63], v96 offset:32768
    v_add_u32 v5, 4, v122
    v_mfma_f32_16x16x32_bf16 v[40:43], a[24:27], a[4:7], v[40:43]
    ds_read_b128 a[64:67], v96 offset:34816
    v_cmp_gt_u32 s[84:85], s6, v5
    v_mfma_f32_16x16x32_bf16 v[44:47], a[24:27], a[8:11], v[44:47]
    ds_read_b128 a[68:71], v96 offset:36864
    s_mul_i32 s4, s4, 7
    v_mfma_f32_16x16x32_bf16 v[48:51], a[24:27], a[12:15], v[48:51]
    ds_read_b128 a[72:75], v96 offset:38912
    s_lshl_b32 s5, s4, 8
    v_mfma_f32_16x16x32_bf16 v[52:55], a[24:27], a[16:19], v[52:55]
    ds_read_b64_tr_b16 a[104:105], v98 offset:49152
    s_add_u32 s78, s78, s5
    s_waitcnt lgkmcnt(10)
    v_mfma_f32_16x16x32_bf16 v[16:19], a[48:51], a[28:31], v[16:19]
    ds_read_b64_tr_b16 a[106:107], v98 offset:50176
    s_mul_i32 s5, s67, 28672
    v_mfma_f32_16x16x32_bf16 v[20:23], a[48:51], a[32:35], v[20:23]
    ds_read_b64_tr_b16 a[108:109], v98 offset:53248
    s_add_u32 s78, s78, s5
    v_mfma_f32_16x16x32_bf16 v[24:27], a[48:51], a[36:39], v[24:27]
    ds_read_b64_tr_b16 a[110:111], v98 offset:54272
    s_and_b32 s4, s4, -4
    v_mfma_f32_16x16x32_bf16 v[28:31], a[48:51], a[40:43], v[28:31]
    ds_read_b128 a[84:87], v97 offset:30720
    s_min_u32 s4, s4, 88
    v_mfma_f32_16x16x32_bf16 v[32:35], a[48:51], a[44:47], v[32:35]
    ds_read_b128 a[88:91], v97 offset:32768
    s_add_u32 s74, s74, s4
    v_mfma_f32_16x16x32_bf16 v[36:39], a[52:55], a[28:31], v[36:39]
    ds_read_b128 a[92:95], v97 offset:34816
    v_mfma_f32_16x16x32_bf16 v[40:43], a[52:55], a[32:35], v[40:43]
    ds_read_b128 a[96:99], v97 offset:36864
    v_mfma_f32_16x16x32_bf16 v[44:47], a[52:55], a[36:39], v[44:47]
    ds_read_b128 a[100:103], v97 offset:38912
    v_mfma_f32_16x16x32_bf16 v[48:51], a[52:55], a[40:43], v[48:51]
    v_mfma_f32_16x16x32_bf16 v[52:55], a[52:55], a[44:47], v[52:55]
    v_add_u32 v96, 40960, v96
    v_add_u32 v97, 40960, v97
    s_waitcnt lgkmcnt(9)
    s_barrier
    v_mfma_f32_16x16x32_bf16 v[16:19], a[76:79], a[56:59], v[16:19]
    ds_read_b64_tr_b16 a[20:21], v98 offset:24576
    s_lshl_b32 s4, s61, 1
    v_mfma_f32_16x16x32_bf16 v[20:23], a[76:79], a[60:63], v[20:23]
    ds_read_b64_tr_b16 a[22:23], v98 offset:25600
    s_add_u32 s4, s4, s67
    v_mfma_f32_16x16x32_bf16 v[24:27], a[76:79], a[64:67], v[24:27]
    ds_read_b64_tr_b16 a[24:25], v98 offset:28672
    s_lshl_b32 s6, s4, 7
    v_mfma_f32_16x16x32_bf16 v[28:31], a[76:79], a[68:71], v[28:31]
    ds_read_b64_tr_b16 a[26:27], v98 offset:29696
    s_add_u32 s6, s6, s76
    v_mfma_f32_16x16x32_bf16 v[32:35], a[76:79], a[72:75], v[32:35]
    ds_read_b128 a[0:3], v96 offset:0
    s_lshl_b32 s6, s6, 2
    v_mfma_f32_16x16x32_bf16 v[36:39], a[80:83], a[56:59], v[36:39]
    ds_read_b128 a[4:7], v96 offset:2048
    s_add_u32 s68, s6, 258048
    v_mfma_f32_16x16x32_bf16 v[40:43], a[80:83], a[60:63], v[40:43]
    ds_read_b128 a[8:11], v96 offset:4096
    s_lshl_b32 s4, s4, 5
    v_mfma_f32_16x16x32_bf16 v[44:47], a[80:83], a[64:67], v[44:47]
    ds_read_b128 a[12:15], v96 offset:6144
    s_add_u32 s4, s4, s76
    v_mfma_f32_16x16x32_bf16 v[48:51], a[80:83], a[68:71], v[48:51]
    ds_read_b128 a[16:19], v96 offset:8192
    s_lshl_b32 s79, s4, 10
    v_mfma_f32_16x16x32_bf16 v[52:55], a[80:83], a[72:75], v[52:55]
    ds_read_b64_tr_b16 a[48:49], v98 offset:32768
    s_add_u32 s80, s79, 16384
    s_waitcnt lgkmcnt(10)
    v_mfma_f32_16x16x32_bf16 v[16:19], a[104:107], a[84:87], v[16:19]
    ds_read_b64_tr_b16 a[50:51], v98 offset:33792
    s_add_u32 s36, s77, 0
    v_mfma_f32_16x16x32_bf16 v[20:23], a[104:107], a[88:91], v[20:23]
    ds_read_b64_tr_b16 a[52:53], v98 offset:36864
    s_add_u32 s37, s77, 28672
    v_mfma_f32_16x16x32_bf16 v[24:27], a[104:107], a[92:95], v[24:27]
    ds_read_b64_tr_b16 a[54:55], v98 offset:37888
    s_add_u32 s38, s77, 57344
    v_mfma_f32_16x16x32_bf16 v[28:31], a[104:107], a[96:99], v[28:31]
    ds_read_b128 a[28:31], v97 offset:0
    s_add_u32 s39, s77, 86016
    v_mfma_f32_16x16x32_bf16 v[32:35], a[104:107], a[100:103], v[32:35]
    ds_read_b128 a[32:35], v97 offset:2048
    s_add_u32 s40, s77, 114688
    v_mfma_f32_16x16x32_bf16 v[36:39], a[108:111], a[84:87], v[36:39]
    ds_read_b128 a[36:39], v97 offset:4096
    v_mfma_f32_16x16x32_bf16 v[40:43], a[108:111], a[88:91], v[40:43]
    ds_read_b128 a[40:43], v97 offset:6144
    v_mfma_f32_16x16x32_bf16 v[44:47], a[108:111], a[92:95], v[44:47]
    ds_read_b128 a[44:47], v97 offset:8192
    v_mfma_f32_16x16x32_bf16 v[48:51], a[108:111], a[96:99], v[48:51]
    v_mfma_f32_16x16x32_bf16 v[52:55], a[108:111], a[100:103], v[52:55]
    s_waitcnt lgkmcnt(9)
    s_barrier
    v_mfma_f32_16x16x32_bf16 v[16:19], a[20:23], a[0:3], v[16:19]
    ds_read_b64_tr_b16 a[76:77], v98 offset:8192
    ds_read_b64_tr_b16 a[78:79], v98 offset:9216
    v_mfma_f32_16x16x32_bf16 v[20:23], a[20:23], a[4:7], v[20:23]
    ds_read_b64_tr_b16 a[80:81], v98 offset:12288
    ds_read_b64_tr_b16 a[82:83], v98 offset:13312
    v_mfma_f32_16x16x32_bf16 v[24:27], a[20:23], a[8:11], v[24:27]
    ds_read_b128 a[56:59], v96 offset:10240
    ds_read_b128 a[60:63], v96 offset:12288
    v_mfma_f32_16x16x32_bf16 v[28:31], a[20:23], a[12:15], v[28:31]
    ds_read_b128 a[64:67], v96 offset:14336
    ds_read_b128 a[68:71], v96 offset:16384
    v_mfma_f32_16x16x32_bf16 v[32:35], a[20:23], a[16:19], v[32:35]
    ds_read_b128 a[72:75], v96 offset:18432
    s_add_u32 s41, s78, 57344
    v_mfma_f32_16x16x32_bf16 v[36:39], a[24:27], a[0:3], v[36:39]
    ds_read_b64_tr_b16 a[104:105], v98 offset:16384
    s_add_u32 s42, s78, 86016
    v_mfma_f32_16x16x32_bf16 v[40:43], a[24:27], a[4:7], v[40:43]
    ds_read_b64_tr_b16 a[106:107], v98 offset:17408
    v_mfma_f32_16x16x32_bf16 v[44:47], a[24:27], a[8:11], v[44:47]
    ds_read_b64_tr_b16 a[108:109], v98 offset:20480
    v_mfma_f32_16x16x32_bf16 v[48:51], a[24:27], a[12:15], v[48:51]
    ds_read_b64_tr_b16 a[110:111], v98 offset:21504
    v_mfma_f32_16x16x32_bf16 v[52:55], a[24:27], a[16:19], v[52:55]
    ds_read_b128 a[84:87], v97 offset:10240
    s_waitcnt lgkmcnt(14)
    v_mfma_f32_16x16x32_bf16 v[16:19], a[48:51], a[28:31], v[16:19]
    ds_read_b128 a[88:91], v97 offset:12288
    v_mfma_f32_16x16x32_bf16 v[20:23], a[48:51], a[32:35], v[20:23]
    ds_read_b128 a[92:95], v97 offset:14336
    v_mfma_f32_16x16x32_bf16 v[24:27], a[48:51], a[36:39], v[24:27]
    ds_read_b128 a[96:99], v97 offset:16384
    v_mfma_f32_16x16x32_bf16 v[28:31], a[48:51], a[40:43], v[28:31]
    ds_read_b128 a[100:103], v97 offset:18432
    v_mfma_f32_16x16x32_bf16 v[32:35], a[48:51], a[44:47], v[32:35]
    ds_read_b64 a[116:117], v104
    v_mfma_f32_16x16x32_bf16 v[36:39], a[52:55], a[28:31], v[36:39]
    ds_read_b64 a[118:119], v105
    v_mfma_f32_16x16x32_bf16 v[40:43], a[52:55], a[32:35], v[40:43]
    ds_read_b64 a[120:121], v106
    v_mfma_f32_16x16x32_bf16 v[44:47], a[52:55], a[36:39], v[44:47]
    ds_read_b64 a[122:123], v107
    v_mfma_f32_16x16x32_bf16 v[48:51], a[52:55], a[40:43], v[48:51]
    v_mfma_f32_16x16x32_bf16 v[52:55], a[52:55], a[44:47], v[52:55]
    s_waitcnt lgkmcnt(13)
    s_barrier
    v_mfma_f32_16x16x32_bf16 v[16:19], a[76:79], a[56:59], v[16:19]
    ds_read_b64_tr_b16 a[20:21], v99 offset:16384
    ds_read_b64_tr_b16 a[22:23], v99 offset:17408
    v_mfma_f32_16x16x32_bf16 v[20:23], a[76:79], a[60:63], v[20:23]
    ds_read_b64_tr_b16 a[24:25], v99 offset:20480
    ds_read_b64_tr_b16 a[26:27], v99 offset:21504
    v_mfma_f32_16x16x32_bf16 v[24:27], a[76:79], a[64:67], v[24:27]
    ds_read_b128 a[0:3], v96 offset:20480
    ds_read_b128 a[4:7], v96 offset:22528
    v_mfma_f32_16x16x32_bf16 v[28:31], a[76:79], a[68:71], v[28:31]
    ds_read_b128 a[8:11], v96 offset:24576
    ds_read_b128 a[12:15], v96 offset:26624
    v_mfma_f32_16x16x32_bf16 v[32:35], a[76:79], a[72:75], v[32:35]
    ds_read_b128 a[16:19], v96 offset:28672
    ds_read_b64_tr_b16 a[48:49], v99 offset:24576
    v_mfma_f32_16x16x32_bf16 v[36:39], a[80:83], a[56:59], v[36:39]
    ds_read_b64_tr_b16 a[50:51], v99 offset:25600
    v_mfma_f32_16x16x32_bf16 v[40:43], a[80:83], a[60:63], v[40:43]
    ds_read_b64_tr_b16 a[52:53], v99 offset:28672
    v_mfma_f32_16x16x32_bf16 v[44:47], a[80:83], a[64:67], v[44:47]
    ds_read_b64_tr_b16 a[54:55], v99 offset:29696
    v_mfma_f32_16x16x32_bf16 v[48:51], a[80:83], a[68:71], v[48:51]
    ds_read_b128 a[28:31], v97 offset:20480
    v_mfma_f32_16x16x32_bf16 v[52:55], a[80:83], a[72:75], v[52:55]
    ds_read_b128 a[32:35], v97 offset:22528
    s_waitcnt lgkmcnt(15)
    v_mfma_f32_16x16x32_bf16 v[16:19], a[104:107], a[84:87], v[16:19]
    ds_read_b128 a[36:39], v97 offset:24576
    v_mfma_f32_16x16x32_bf16 v[20:23], a[104:107], a[88:91], v[20:23]
    ds_read_b128 a[40:43], v97 offset:26624
    v_mfma_f32_16x16x32_bf16 v[24:27], a[104:107], a[92:95], v[24:27]
    ds_read_b128 a[44:47], v97 offset:28672
    v_mfma_f32_16x16x32_bf16 v[28:31], a[104:107], a[96:99], v[28:31]
    ds_read2_b32 v[56:57], v102 offset0:0 offset1:128
    v_mfma_f32_16x16x32_bf16 v[32:35], a[104:107], a[100:103], v[32:35]
    ds_read2_b32 v[58:59], v102 offset0:16 offset1:144
    v_mfma_f32_16x16x32_bf16 v[36:39], a[108:111], a[84:87], v[36:39]
    ds_read2_b32 v[60:61], v102 offset0:32 offset1:160
    v_mfma_f32_16x16x32_bf16 v[40:43], a[108:111], a[88:91], v[40:43]
    ds_read2_b32 v[62:63], v102 offset0:48 offset1:176
    v_mfma_f32_16x16x32_bf16 v[44:47], a[108:111], a[92:95], v[44:47]
    ds_read2_b32 v[64:65], v102 offset0:64 offset1:192
    v_mfma_f32_16x16x32_bf16 v[48:51], a[108:111], a[96:99], v[48:51]
    v_mfma_f32_16x16x32_bf16 v[52:55], a[108:111], a[100:103], v[52:55]
    s_waitcnt lgkmcnt(0)
    v_mfma_f32_16x16x32_bf16 v[36:39], a[24:27], a[0:3], v[36:39]
    v_mul_f32 v68, 1049335798, v59
    v_mfma_f32_16x16x32_bf16 v[40:43], a[24:27], a[4:7], v[40:43]
    s_branch Lsk3
Lstub3:
    s_setpc_b64 s[28:29]
Lsk3:
    v_mul_f32 v69, 1049335798, v61
    v_mfma_f32_16x16x32_bf16 v[44:47], a[24:27], a[8:11], v[44:47]
    v_mul_f32 v70, 1049335798, v63
    v_mfma_f32_16x16x32_bf16 v[48:51], a[24:27], a[12:15], v[48:51]
    v_mul_f32 v71, 1049335798, v65
    v_mfma_f32_16x16x32_bf16 v[52:55], a[24:27], a[16:19], v[52:55]
    v_mfma_f32_16x16x32_bf16 v[36:39], a[52:55], a[28:31], v[36:39]
    v_mfma_f32_16x16x32_bf16 v[40:43], a[52:55], a[32:35], v[40:43]
    v_mfma_f32_16x16x32_bf16 v[44:47], a[52:55], a[36:39], v[44:47]
    v_mfma_f32_16x16x32_bf16 v[48:51], a[52:55], a[40:43], v[48:51]
    v_mfma_f32_16x16x32_bf16 v[52:55], a[52:55], a[44:47], v[52:55]
    v_mfma_f32_16x16x32_bf16 v[16:19], a[20:23], a[0:3], v[16:19]
    v_mfma_f32_16x16x32_bf16 v[20:23], a[20:23], a[4:7], v[20:23]
    v_mfma_f32_16x16x32_bf16 v[24:27], a[20:23], a[8:11], v[24:27]
    v_mfma_f32_16x16x32_bf16 v[28:31], a[20:23], a[12:15], v[28:31]
    v_mfma_f32_16x16x32_bf16 v[32:35], a[20:23], a[16:19], v[32:35]
    v_fmac_f32_dpp v40, v36, v58 row_newbcast:0 row_mask:0xf bank_mask:0xf
    v_fmac_f32_dpp v41, v37, v58 row_newbcast:0 row_mask:0xf bank_mask:0xf
    v_mfma_f32_16x16x32_bf16 v[16:19], a[48:51], a[28:31], v[16:19]
    v_fmac_f32_dpp v42, v38, v58 row_newbcast:0 row_mask:0xf bank_mask:0xf
    v_fmac_f32_dpp v43, v39, v58 row_newbcast:0 row_mask:0xf bank_mask:0xf
    v_mfma_f32_16x16x32_bf16 v[20:23], a[48:51], a[32:35], v[20:23]
    v_fmac_f32_dpp v44, v36, v60 row_newbcast:0 row_mask:0xf bank_mask:0xf
    v_fmac_f32_dpp v45, v37, v60 row_newbcast:0 row_mask:0xf bank_mask:0xf
    v_mfma_f32_16x16x32_bf16 v[24:27], a[48:51], a[36:39], v[24:27]
    v_fmac_f32_dpp v46, v38, v60 row_newbcast:0 row_mask:0xf bank_mask:0xf
    v_fmac_f32_dpp v47, v39, v60 row_newbcast:0 row_mask:0xf bank_mask:0xf
    v_mfma_f32_16x16x32_bf16 v[28:31], a[48:51], a[40:43], v[28:31]
    v_fmac_f32_dpp v48, v36, v62 row_newbcast:0 row_mask:0xf bank_mask:0xf
    v_fmac_f32_dpp v49, v37, v62 row_newbcast:0 row_mask:0xf bank_mask:0xf
    v_mfma_f32_16x16x32_bf16 v[32:35], a[48:51], a[44:47], v[32:35]
    v_fmac_f32_dpp v50, v38, v62 row_newbcast:0 row_mask:0xf bank_mask:0xf
    v_fmac_f32_dpp v51, v39, v62 row_newbcast:0 row_mask:0xf bank_mask:0xf
    v_fmac_f32_dpp v52, v36, v64 row_newbcast:0 row_mask:0xf bank_mask:0xf
    v_fmac_f32_dpp v53, v37, v64 row_newbcast:0 row_mask:0xf bank_mask:0xf
    v_fmac_f32_dpp v54, v38, v64 row_newbcast:0 row_mask:0xf bank_mask:0xf
    v_fmac_f32_dpp v55, v39, v64 row_newbcast:0 row_mask:0xf bank_mask:0xf
    v_fmac_f32_dpp v36, v36, v56 row_newbcast:0 row_mask:0xf bank_mask:0xf
    v_fmac_f32_dpp v37, v37, v56 row_newbcast:0 row_mask:0xf bank_mask:0xf
    v_fmac_f32_dpp v38, v38, v56 row_newbcast:0 row_mask:0xf bank_mask:0xf
    v_fmac_f32_dpp v39, v39, v56 row_newbcast:0 row_mask:0xf bank_mask:0xf
    buffer_load_dword v1, v125, s[56:59], s43 offen sc1
    v_pk_mul_f32 v[40:41], v[40:41], v[58:59] op_sel:[0,1] op_sel_hi:[1,1]
    v_pk_mul_f32 v[42:43], v[42:43], v[58:59] op_sel:[0,1] op_sel_hi:[1,1]
    v_cvt_pk_bf16_f32 v84, v40, v41
    v_cvt_pk_bf16_f32 v85, v42, v43
    v_pk_mul_f32 v[44:45], v[44:45], v[60:61] op_sel:[0,1] op_sel_hi:[1,1]
    v_pk_mul_f32 v[46:47], v[46:47], v[60:61] op_sel:[0,1] op_sel_hi:[1,1]
    v_cvt_pk_bf16_f32 v86, v44, v45
    v_cvt_pk_bf16_f32 v87, v46, v47
    buffer_store_dwordx4 v[84:87], v14, s[56:59], s39 offen sc1
    v_pk_mul_f32 v[48:49], v[48:49], v[62:63] op_sel:[0,1] op_sel_hi:[1,1]
    v_pk_mul_f32 v[50:51], v[50:51], v[62:63] op_sel:[0,1] op_sel_hi:[1,1]
    v_cvt_pk_bf16_f32 v88, v48, v49
    v_cvt_pk_bf16_f32 v89, v50, v51
    v_pk_mul_f32 v[52:53], v[52:53], v[64:65] op_sel:[0,1] op_sel_hi:[1,1]
    v_pk_mul_f32 v[54:55], v[54:55], v[64:65] op_sel:[0,1] op_sel_hi:[1,1]
    v_cvt_pk_bf16_f32 v90, v52, v53
    v_cvt_pk_bf16_f32 v91, v54, v55
    buffer_store_dwordx4 v[88:91], v14, s[56:59], s40 offen sc1
    v_pk_mul_f32 v[36:37], v[36:37], v[56:57] op_sel:[0,1] op_sel_hi:[1,1]
    v_pk_mul_f32 v[38:39], v[38:39], v[56:57] op_sel:[0,1] op_sel_hi:[1,1]
    v_cvt_pk_bf16_f32 v82, v36, v37
    v_cvt_pk_bf16_f32 v83, v38, v39
    buffer_store_dwordx4 v[80:83], v14, s[56:59], s38 offen sc1
    v_fmac_f32_dpp v20, v16, v58 row_newbcast:0 row_mask:0xf bank_mask:0xf
    v_fmac_f32_dpp v21, v17, v58 row_newbcast:0 row_mask:0xf bank_mask:0xf
    v_fmac_f32_dpp v22, v18, v58 row_newbcast:0 row_mask:0xf bank_mask:0xf
    v_fmac_f32_dpp v23, v19, v58 row_newbcast:0 row_mask:0xf bank_mask:0xf
    v_fmac_f32_dpp v24, v16, v60 row_newbcast:0 row_mask:0xf bank_mask:0xf
    v_fmac_f32_dpp v25, v17, v60 row_newbcast:0 row_mask:0xf bank_mask:0xf
    v_fmac_f32_dpp v26, v18, v60 row_newbcast:0 row_mask:0xf bank_mask:0xf
    v_fmac_f32_dpp v27, v19, v60 row_newbcast:0 row_mask:0xf bank_mask:0xf
    v_fmac_f32_dpp v28, v16, v62 row_newbcast:0 row_mask:0xf bank_mask:0xf
    v_fmac_f32_dpp v29, v17, v62 row_newbcast:0 row_mask:0xf bank_mask:0xf
    v_fmac_f32_dpp v30, v18, v62 row_newbcast:0 row_mask:0xf bank_mask:0xf
    v_fmac_f32_dpp v31, v19, v62 row_newbcast:0 row_mask:0xf bank_mask:0xf
    v_fmac_f32_dpp v32, v16, v64 row_newbcast:0 row_mask:0xf bank_mask:0xf
    v_fmac_f32_dpp v33, v17, v64 row_newbcast:0 row_mask:0xf bank_mask:0xf
    v_fmac_f32_dpp v34, v18, v64 row_newbcast:0 row_mask:0xf bank_mask:0xf
    v_fmac_f32_dpp v35, v19, v64 row_newbcast:0 row_mask:0xf bank_mask:0xf
    v_pk_mul_f32 v[20:21], v[20:21], v[68:69] op_sel:[0,0] op_sel_hi:[1,0]
    v_pk_mul_f32 v[22:23], v[22:23], v[68:69] op_sel:[0,0] op_sel_hi:[1,0]
    v_cvt_pk_bf16_f32 v72, v20, v21
    v_cvt_pk_bf16_f32 v73, v22, v23
    v_pk_mul_f32 v[24:25], v[24:25], v[68:69] op_sel:[0,1] op_sel_hi:[1,1]
    v_pk_mul_f32 v[26:27], v[26:27], v[68:69] op_sel:[0,1] op_sel_hi:[1,1]
    v_cvt_pk_bf16_f32 v74, v24, v25
    v_cvt_pk_bf16_f32 v75, v26, v27
    buffer_store_dwordx4 v[72:75], v14, s[56:59], s36 offen sc1
    v_pk_mul_f32 v[28:29], v[28:29], v[70:71] op_sel:[0,0] op_sel_hi:[1,0]
    v_pk_mul_f32 v[30:31], v[30:31], v[70:71] op_sel:[0,0] op_sel_hi:[1,0]
    v_cvt_pk_bf16_f32 v76, v28, v29
    v_cvt_pk_bf16_f32 v77, v30, v31
    v_pk_mul_f32 v[32:33], v[32:33], v[70:71] op_sel:[0,1] op_sel_hi:[1,1]
    v_pk_mul_f32 v[34:35], v[34:35], v[70:71] op_sel:[0,1] op_sel_hi:[1,1]
    v_cvt_pk_bf16_f32 v78, v32, v33
    v_cvt_pk_bf16_f32 v79, v34, v35
    buffer_store_dwordx4 v[76:79], v14, s[56:59], s37 offen sc1
    s_barrier
    ds_read_b128 a[0:3], v4 offset:0
    ds_read_b64_tr_b16 a[12:13], v120 offset:0
    ds_read_b128 a[4:7], v2 offset:2048
    ds_read_b64_tr_b16 a[14:15], v120 offset:1024
    ds_read_b128 a[8:11], v2 offset:4096
    ds_read_b64_tr_b16 a[16:17], v121 offset:0
    ds_read_b64_tr_b16 a[18:19], v121 offset:1024
    ds_read_b128 a[20:23], v8 offset:0
    ds_read_b64_tr_b16 a[32:33], v120 offset:4096
    ds_read_b128 a[24:27], v3 offset:2048
    ds_read_b64_tr_b16 a[34:35], v120 offset:5120
    ds_read_b128 a[28:31], v3 offset:4096
    ds_read_b64_tr_b16 a[36:37], v121 offset:4096
    ds_read_b64_tr_b16 a[38:39], v121 offset:5120
    s_waitcnt lgkmcnt(7)
    v_mfma_f32_16x16x32_bf16 v[16:19], a[0:3], a[12:15], 0
    ds_read_b128 a[40:43], v4 offset:10240
    v_mfma_f32_16x16x32_bf16 v[24:27], a[4:7], a[12:15], 0
    ds_read_b64_tr_b16 a[52:53], v120 offset:8192
    v_mfma_f32_16x16x32_bf16 v[32:35], a[8:11], a[12:15], 0
    ds_read_b128 a[44:47], v2 offset:12288
    v_mfma_f32_16x16x32_bf16 v[20:23], a[0:3], a[16:19], 0
    ds_read_b64_tr_b16 a[54:55], v120 offset:9216
    v_mfma_f32_16x16x32_bf16 v[28:31], a[4:7], a[16:19], 0
    ds_read_b128 a[48:51], v2 offset:14336
    v_mfma_f32_16x16x32_bf16 v[36:39], a[8:11], a[16:19], 0
    ds_read_b64_tr_b16 a[56:57], v121 offset:8192
    ds_read_b64_tr_b16 a[58:59], v121 offset:9216
    s_waitcnt lgkmcnt(7)
    v_mfma_f32_16x16x32_bf16 v[16:19], a[20:23], a[32:35], v[16:19]
    ds_read_b128 a[60:63], v8 offset:10240
    v_mfma_f32_16x16x32_bf16 v[24:27], a[24:27], a[32:35], v[24:27]
    ds_read_b64_tr_b16 a[72:73], v120 offset:12288
    v_mfma_f32_16x16x32_bf16 v[32:35], a[28:31], a[32:35], v[32:35]
    ds_read_b128 a[64:67], v3 offset:12288
    v_mfma_f32_16x16x32_bf16 v[20:23], a[20:23], a[36:39], v[20:23]
    ds_read_b64_tr_b16 a[74:75], v120 offset:13312
    v_mfma_f32_16x16x32_bf16 v[28:31], a[24:27], a[36:39], v[28:31]
    ds_read_b128 a[68:71], v3 offset:14336
    v_mfma_f32_16x16x32_bf16 v[36:39], a[28:31], a[36:39], v[36:39]
    ds_read_b64_tr_b16 a[76:77], v121 offset:12288
    ds_read_b64_tr_b16 a[78:79], v121 offset:13312
    s_waitcnt lgkmcnt(7)
    v_mfma_f32_16x16x32_bf16 v[16:19], a[40:43], a[52:55], v[16:19]
    ds_read_b128 a[0:3], v4 offset:20480
    v_mfma_f32_16x16x32_bf16 v[24:27], a[44:47], a[52:55], v[24:27]
    ds_read_b64_tr_b16 a[12:13], v118 offset:40960
    v_mfma_f32_16x16x32_bf16 v[32:35], a[48:51], a[52:55], v[32:35]
    ds_read_b128 a[4:7], v2 offset:22528
    v_mfma_f32_16x16x32_bf16 v[20:23], a[40:43], a[56:59], v[20:23]
    ds_read_b64_tr_b16 a[14:15], v118 offset:41984
    v_mfma_f32_16x16x32_bf16 v[28:31], a[44:47], a[56:59], v[28:31]
    ds_read_b128 a[8:11], v2 offset:24576
    v_mfma_f32_16x16x32_bf16 v[36:39], a[48:51], a[56:59], v[36:39]
    ds_read_b64_tr_b16 a[16:17], v119 offset:40960
    ds_read_b64_tr_b16 a[18:19], v119 offset:41984
    s_waitcnt lgkmcnt(7)
    v_mfma_f32_16x16x32_bf16 v[16:19], a[60:63], a[72:75], v[16:19]
    ds_read_b128 a[20:23], v8 offset:20480
    v_mfma_f32_16x16x32_bf16 v[24:27], a[64:67], a[72:75], v[24:27]
    ds_read_b64_tr_b16 a[32:33], v118 offset:45056
    v_mfma_f32_16x16x32_bf16 v[32:35], a[68:71], a[72:75], v[32:35]
    ds_read_b128 a[24:27], v3 offset:22528
    v_mfma_f32_16x16x32_bf16 v[20:23], a[60:63], a[76:79], v[20:23]
    ds_read_b64_tr_b16 a[34:35], v118 offset:46080
    v_mfma_f32_16x16x32_bf16 v[28:31], a[64:67], a[76:79], v[28:31]
    ds_read_b128 a[28:31], v3 offset:24576
    v_mfma_f32_16x16x32_bf16 v[36:39], a[68:71], a[76:79], v[36:39]
    ds_read_b64_tr_b16 a[36:37], v119 offset:45056
    ds_read_b64_tr_b16 a[38:39], v119 offset:46080
    s_waitcnt lgkmcnt(7)
    v_mfma_f32_16x16x32_bf16 v[16:19], a[0:3], a[12:15], v[16:19]
    ds_read_b128 a[40:43], v4 offset:30720
    v_mfma_f32_16x16x32_bf16 v[24:27], a[4:7], a[12:15], v[24:27]
    ds_read_b64_tr_b16 a[52:53], v118 offset:49152
    v_mfma_f32_16x16x32_bf16 v[32:35], a[8:11], a[12:15], v[32:35]
    ds_read_b128 a[44:47], v2 offset:32768
    v_mfma_f32_16x16x32_bf16 v[20:23], a[0:3], a[16:19], v[20:23]
    ds_read_b64_tr_b16 a[54:55], v118 offset:50176
    v_mfma_f32_16x16x32_bf16 v[28:31], a[4:7], a[16:19], v[28:31]
    ds_read_b128 a[48:51], v2 offset:34816
    v_mfma_f32_16x16x32_bf16 v[36:39], a[8:11], a[16:19], v[36:39]
    ds_read_b64_tr_b16 a[56:57], v119 offset:49152
    ds_read_b64_tr_b16 a[58:59], v119 offset:50176
    v_add_u32 v2, 40960, v2
    v_add_u32 v4, 40960, v4
    s_waitcnt vmcnt(5)
    s_mov_b64 exec, 0x3fff
    s_mov_b32 s81, 0
Lid:
    v_xor_b32 v1, s69, v1
    v_cmp_lt_u32 vcc, 15, v1
    s_nop 0
    s_cbranch_vccnz Lidf
Lidk:
    v_cmp_ne_u32 vcc, 0, v1
    s_nop 0
    s_cmp_eq_u64 vcc, 0
    s_cselect_b32 s69, 1, 0
    s_mov_b64 exec, -1
    s_waitcnt lgkmcnt(7)
    v_mfma_f32_16x16x32_bf16 v[16:19], a[20:23], a[32:35], v[16:19]
    ds_read_b128 a[60:63], v8 offset:30720
    v_mfma_f32_16x16x32_bf16 v[24:27], a[24:27], a[32:35], v[24:27]
    ds_read_b64_tr_b16 a[72:73], v118 offset:53248
    v_mfma_f32_16x16x32_bf16 v[32:35], a[28:31], a[32:35], v[32:35]
    ds_read_b128 a[64:67], v3 offset:32768
    v_mfma_f32_16x16x32_bf16 v[20:23], a[20:23], a[36:39], v[20:23]
    ds_read_b64_tr_b16 a[74:75], v118 offset:54272
    v_mfma_f32_16x16x32_bf16 v[28:31], a[24:27], a[36:39], v[28:31]
    ds_read_b128 a[68:71], v3 offset:34816
    v_mfma_f32_16x16x32_bf16 v[36:39], a[28:31], a[36:39], v[36:39]
    ds_read_b64_tr_b16 a[76:77], v119 offset:53248
    ds_read_b64_tr_b16 a[78:79], v119 offset:54272
    v_add_u32 v3, 40960, v3
    v_add_u32 v8, 40960, v8
    s_waitcnt lgkmcnt(7)
    v_mfma_f32_16x16x32_bf16 v[16:19], a[40:43], a[52:55], v[16:19]
    ds_read_b128 a[0:3], v4 offset:0
    v_mfma_f32_16x16x32_bf16 v[24:27], a[44:47], a[52:55], v[24:27]
    ds_read_b64_tr_b16 a[12:13], v118 offset:24576
    v_mfma_f32_16x16x32_bf16 v[32:35], a[48:51], a[52:55], v[32:35]
    ds_read_b128 a[4:7], v2 offset:2048
    v_mfma_f32_16x16x32_bf16 v[20:23], a[40:43], a[56:59], v[20:23]
    ds_read_b64_tr_b16 a[14:15], v118 offset:25600
    v_mfma_f32_16x16x32_bf16 v[28:31], a[44:47], a[56:59], v[28:31]
    ds_read_b128 a[8:11], v2 offset:4096
    v_mfma_f32_16x16x32_bf16 v[36:39], a[48:51], a[56:59], v[36:39]
    ds_read_b64_tr_b16 a[16:17], v119 offset:24576
    ds_read_b64_tr_b16 a[18:19], v119 offset:25600
    s_waitcnt lgkmcnt(7)
    v_mfma_f32_16x16x32_bf16 v[16:19], a[60:63], a[72:75], v[16:19]
    ds_read_b128 a[20:23], v8 offset:0
    v_mfma_f32_16x16x32_bf16 v[24:27], a[64:67], a[72:75], v[24:27]
    ds_read_b64_tr_b16 a[32:33], v118 offset:28672
    v_mfma_f32_16x16x32_bf16 v[32:35], a[68:71], a[72:75], v[32:35]
    ds_read_b128 a[24:27], v3 offset:2048
    v_mfma_f32_16x16x32_bf16 v[20:23], a[60:63], a[76:79], v[20:23]
    ds_read_b64_tr_b16 a[34:35], v118 offset:29696
    v_mfma_f32_16x16x32_bf16 v[28:31], a[64:67], a[76:79], v[28:31]
    ds_read_b128 a[28:31], v3 offset:4096
    v_mfma_f32_16x16x32_bf16 v[36:39], a[68:71], a[76:79], v[36:39]
    ds_read_b64_tr_b16 a[36:37], v119 offset:28672
    ds_read_b64_tr_b16 a[38:39], v119 offset:29696
    s_waitcnt lgkmcnt(7)
    v_mfma_f32_16x16x32_bf16 v[16:19], a[0:3], a[12:15], v[16:19]
    ds_read_b128 a[40:43], v4 offset:10240
    v_mfma_f32_16x16x32_bf16 v[24:27], a[4:7], a[12:15], v[24:27]
    ds_read_b64_tr_b16 a[52:53], v118 offset:32768
    v_mfma_f32_16x16x32_bf16 v[32:35], a[8:11], a[12:15], v[32:35]
    ds_read_b128 a[44:47], v2 offset:12288
    v_mfma_f32_16x16x32_bf16 v[20:23], a[0:3], a[16:19], v[20:23]
    ds_read_b64_tr_b16 a[54:55], v118 offset:33792
    v_mfma_f32_16x16x32_bf16 v[28:31], a[4:7], a[16:19], v[28:31]
    ds_read_b128 a[48:51], v2 offset:14336
    v_mfma_f32_16x16x32_bf16 v[36:39], a[8:11], a[16:19], v[36:39]
    ds_read_b64_tr_b16 a[56:57], v119 offset:32768
    ds_read_b64_tr_b16 a[58:59], v119 offset:33792
    s_waitcnt lgkmcnt(7)
    v_mfma_f32_16x16x32_bf16 v[16:19], a[20:23], a[32:35], v[16:19]
    ds_read_b128 a[60:63], v8 offset:10240
    v_mfma_f32_16x16x32_bf16 v[24:27], a[24:27], a[32:35], v[24:27]
    ds_read_b64_tr_b16 a[72:73], v118 offset:36864
    v_mfma_f32_16x16x32_bf16 v[32:35], a[28:31], a[32:35], v[32:35]
    ds_read_b128 a[64:67], v3 offset:12288
    v_mfma_f32_16x16x32_bf16 v[20:23], a[20:23], a[36:39], v[20:23]
    ds_read_b64_tr_b16 a[74:75], v118 offset:37888
    v_mfma_f32_16x16x32_bf16 v[28:31], a[24:27], a[36:39], v[28:31]
    ds_read_b128 a[68:71], v3 offset:14336
    v_mfma_f32_16x16x32_bf16 v[36:39], a[28:31], a[36:39], v[36:39]
    ds_read_b64_tr_b16 a[76:77], v119 offset:36864
    ds_read_b64_tr_b16 a[78:79], v119 offset:37888
    s_waitcnt vmcnt(0)
    s_cmp_eq_u32 s69, 0
    s_cbranch_scc1 Lfs0
    buffer_store_dword v15, v11, s[56:59], 0 offen
Lfd0:
    s_barrier
    s_waitcnt lgkmcnt(7)
    v_mfma_f32_16x16x32_bf16 v[16:19], a[40:43], a[52:55], v[16:19]
    ds_read_b128 a[0:3], v4 offset:20480
    v_mfma_f32_16x16x32_bf16 v[24:27], a[44:47], a[52:55], v[24:27]
    ds_read_b64_tr_b16 a[12:13], v118 offset:0
    v_mfma_f32_16x16x32_bf16 v[32:35], a[48:51], a[52:55], v[32:35]
    ds_read_b128 a[4:7], v2 offset:22528
    v_mfma_f32_16x16x32_bf16 v[20:23], a[40:43], a[56:59], v[20:23]
    ds_read_b64_tr_b16 a[14:15], v118 offset:1024
    v_mfma_f32_16x16x32_bf16 v[28:31], a[44:47], a[56:59], v[28:31]
    ds_read_b128 a[8:11], v2 offset:24576
    v_mfma_f32_16x16x32_bf16 v[36:39], a[48:51], a[56:59], v[36:39]
    ds_read_b64_tr_b16 a[16:17], v119 offset:0
    ds_read_b64_tr_b16 a[18:19], v119 offset:1024
    s_waitcnt lgkmcnt(7)
    v_mfma_f32_16x16x32_bf16 v[16:19], a[60:63], a[72:75], v[16:19]
    ds_read_b128 a[20:23], v8 offset:20480
    v_mfma_f32_16x16x32_bf16 v[24:27], a[64:67], a[72:75], v[24:27]
    ds_read_b64_tr_b16 a[32:33], v118 offset:4096
    v_mfma_f32_16x16x32_bf16 v[32:35], a[68:71], a[72:75], v[32:35]
    ds_read_b128 a[24:27], v3 offset:22528
    v_mfma_f32_16x16x32_bf16 v[20:23], a[60:63], a[76:79], v[20:23]
    ds_read_b64_tr_b16 a[34:35], v118 offset:5120
    v_mfma_f32_16x16x32_bf16 v[28:31], a[64:67], a[76:79], v[28:31]
    ds_read_b128 a[28:31], v3 offset:24576
    v_mfma_f32_16x16x32_bf16 v[36:39], a[68:71], a[76:79], v[36:39]
    ds_read_b64_tr_b16 a[36:37], v119 offset:4096
    ds_read_b64_tr_b16 a[38:39], v119 offset:5120
    s_waitcnt lgkmcnt(7)
    v_mfma_f32_16x16x32_bf16 v[16:19], a[0:3], a[12:15], v[16:19]
    ds_read_b128 v[40:43], v116 offset:0
    v_mfma_f32_16x16x32_bf16 v[24:27], a[4:7], a[12:15], v[24:27]
    ds_read_b128 v[44:47], v116 offset:64
    v_mfma_f32_16x16x32_bf16 v[32:35], a[8:11], a[12:15], v[32:35]
    ds_read_b128 v[48:51], v116 offset:128
    v_mfma_f32_16x16x32_bf16 v[20:23], a[0:3], a[16:19], v[20:23]
    ds_read_b128 v[52:55], v116 offset:512
    v_mfma_f32_16x16x32_bf16 v[28:31], a[4:7], a[16:19], v[28:31]
    ds_read_b128 v[56:59], v116 offset:576
    v_mfma_f32_16x16x32_bf16 v[36:39], a[8:11], a[16:19], v[36:39]
    ds_read_b128 v[60:63], v116 offset:640
    s_waitcnt lgkmcnt(6)
    v_mfma_f32_16x16x32_bf16 v[16:19], a[20:23], a[32:35], v[16:19]
    v_mfma_f32_16x16x32_bf16 v[24:27], a[24:27], a[32:35], v[24:27]
    v_mfma_f32_16x16x32_bf16 v[32:35], a[28:31], a[32:35], v[32:35]
    v_mfma_f32_16x16x32_bf16 v[20:23], a[20:23], a[36:39], v[20:23]
    v_mfma_f32_16x16x32_bf16 v[28:31], a[24:27], a[36:39], v[28:31]
    v_mfma_f32_16x16x32_bf16 v[36:39], a[28:31], a[36:39], v[36:39]
    s_waitcnt lgkmcnt(0)
    s_load_dwordx8 s[8:15], s[56:57], s74
    s_nop 0
    v_mov_b32 v2, v16
    v_mov_b32 v6, v16
    s_nop 0
    v_mov_b32 v3, v20
    v_mov_b32 v7, v20
    v_add_u32 v11, s68, v124
    v_permlane16_swap_b32 v2, v6
    v_permlane16_swap_b32 v3, v7
    v_mov_b32 v6, v2
    v_mov_b32 v7, v3
    s_nop 0
    v_permlane32_swap_b32 v2, v6
    v_permlane32_swap_b32 v3, v7
    v_pk_fma_f32 v[16:17], v[2:3], v[40:41], v[16:17] op_sel:[0,0,0] op_sel_hi:[0,1,1]
    v_pk_fma_f32 v[18:19], v[2:3], v[42:43], v[18:19] op_sel:[0,0,0] op_sel_hi:[0,1,1]
    v_pk_fma_f32 v[20:21], v[2:3], v[40:41], v[20:21] op_sel:[1,0,0] op_sel_hi:[1,1,1]
    v_pk_fma_f32 v[22:23], v[2:3], v[42:43], v[22:23] op_sel:[1,0,0] op_sel_hi:[1,1,1]
    v_pk_fma_f32 v[24:25], v[2:3], v[44:45], v[24:25] op_sel:[0,0,0] op_sel_hi:[0,1,1]
    v_pk_fma_f32 v[26:27], v[2:3], v[46:47], v[26:27] op_sel:[0,0,0] op_sel_hi:[0,1,1]
    v_pk_fma_f32 v[28:29], v[2:3], v[44:45], v[28:29] op_sel:[1,0,0] op_sel_hi:[1,1,1]
    v_pk_fma_f32 v[30:31], v[2:3], v[46:47], v[30:31] op_sel:[1,0,0] op_sel_hi:[1,1,1]
    v_pk_fma_f32 v[32:33], v[2:3], v[48:49], v[32:33] op_sel:[0,0,0] op_sel_hi:[0,1,1]
    v_pk_fma_f32 v[34:35], v[2:3], v[50:51], v[34:35] op_sel:[0,0,0] op_sel_hi:[0,1,1]
    v_pk_fma_f32 v[36:37], v[2:3], v[48:49], v[36:37] op_sel:[1,0,0] op_sel_hi:[1,1,1]
    v_pk_fma_f32 v[38:39], v[2:3], v[50:51], v[38:39] op_sel:[1,0,0] op_sel_hi:[1,1,1]
    v_pk_mul_f32 v[16:17], v[16:17], v[52:53]
    v_pk_mul_f32 v[18:19], v[18:19], v[54:55]
    v_pk_mul_f32 v[20:21], v[20:21], v[52:53]
    v_pk_mul_f32 v[22:23], v[22:23], v[54:55]
    v_pk_mul_f32 v[24:25], v[24:25], v[56:57]
    v_pk_mul_f32 v[26:27], v[26:27], v[58:59]
    v_pk_mul_f32 v[28:29], v[28:29], v[56:57]
    v_pk_mul_f32 v[30:31], v[30:31], v[58:59]
    v_pk_mul_f32 v[32:33], v[32:33], v[60:61]
    v_pk_mul_f32 v[34:35], v[34:35], v[62:63]
    v_pk_mul_f32 v[36:37], v[36:37], v[60:61]
    v_pk_mul_f32 v[38:39], v[38:39], v[62:63]
    v_cvt_pk_bf16_f32 v16, v16, v17
    v_cvt_pk_bf16_f32 v18, v18, v19
    v_cvt_pk_bf16_f32 v20, v20, v21
    v_cvt_pk_bf16_f32 v22, v22, v23
    v_cvt_pk_bf16_f32 v24, v24, v25
    s_branch Lpq
Lpfq:
    s_add_u32 s74, s74, 128
    s_and_b32 s81, s74, 896
    s_cbranch_scc0 Lpvq
    s_load_dwordx8 s[8:15], s[56:57], s74
Lpq:
    s_waitcnt lgkmcnt(0)
    s_xor_b64 s[8:9], s[8:9], s[26:27]
    s_xor_b64 s[10:11], s[10:11], s[26:27]
    s_or_b64 s[8:9], s[8:9], s[10:11]
    s_xor_b64 s[12:13], s[12:13], s[26:27]
    s_or_b64 s[8:9], s[8:9], s[12:13]
    s_cbranch_scc1 Lpfq
Lpkq:
    buffer_load_dwordx4 v[64:67], v14, s[56:59], s78 offen offset:0 sc1
    buffer_load_dwordx4 v[68:71], v12, s[56:59], s78 offen offset:1024 sc1
    buffer_load_dwordx4 v[80:83], v14, s[56:59], s42 offen offset:0 sc1
    buffer_load_dwordx4 v[84:87], v12, s[56:59], s42 offen offset:1024 sc1
    buffer_load_dwordx2 v[96:97], v14, s[56:59], s41 offen offset:8 sc1
    buffer_load_dwordx2 v[98:99], v12, s[56:59], s41 offen offset:1032 sc1
    buffer_load_dwordx4 v[72:75], v14, s[56:59], s78 offen offset:1792 sc1
    buffer_load_dwordx4 v[76:79], v12, s[56:59], s78 offen offset:2816 sc1
    buffer_load_dwordx4 v[88:91], v14, s[56:59], s42 offen offset:1792 sc1
    buffer_load_dwordx4 v[92:95], v12, s[56:59], s42 offen offset:2816 sc1
    buffer_load_dwordx2 v[100:101], v14, s[56:59], s41 offen offset:1800 sc1
    buffer_load_dwordx2 v[102:103], v12, s[56:59], s41 offen offset:2824 sc1
    s_barrier
    v_cvt_pk_bf16_f32 v26, v26, v27
    v_cvt_pk_bf16_f32 v28, v28, v29
    v_cvt_pk_bf16_f32 v30, v30, v31
    v_cvt_pk_bf16_f32 v32, v32, v33
    v_cvt_pk_bf16_f32 v34, v34, v35
    v_cvt_pk_bf16_f32 v36, v36, v37
    v_cvt_pk_bf16_f32 v38, v38, v39
    v_cndmask_b32 v104, 0, v16, s[82:83]
    v_cndmask_b32 v16, v16, 0, s[82:83]
    v_cndmask_b32 v105, 0, v18, s[82:83]
    v_cndmask_b32 v18, v18, 0, s[82:83]
    v_cndmask_b32 v110, 0, v20, s[84:85]
    v_cndmask_b32 v20, v20, 0, s[84:85]
    v_cndmask_b32 v111, 0, v22, s[84:85]
    v_cndmask_b32 v22, v22, 0, s[84:85]
    v_cndmask_b32 v106, 0, v24, s[82:83]
    v_cndmask_b32 v24, v24, 0, s[82:83]
    v_cndmask_b32 v107, 0, v26, s[82:83]
    v_cndmask_b32 v26, v26, 0, s[82:83]
    v_cndmask_b32 v112, 0, v28, s[84:85]
    v_cndmask_b32 v28, v28, 0, s[84:85]
    v_cndmask_b32 v113, 0, v30, s[84:85]
    v_cndmask_b32 v30, v30, 0, s[84:85]
    v_cndmask_b32 v108, 0, v32, s[82:83]
    v_cndmask_b32 v32, v32, 0, s[82:83]
    v_cndmask_b32 v109, 0, v34, s[82:83]
    v_cndmask_b32 v34, v34, 0, s[82:83]
    v_cndmask_b32 v114, 0, v36, s[84:85]
    v_cndmask_b32 v36, v36, 0, s[84:85]
    v_cndmask_b32 v115, 0, v38, s[84:85]
    v_cndmask_b32 v38, v38, 0, s[84:85]
    v_accvgpr_write_b32 a0, v16
    v_accvgpr_write_b32 a1, v18
    v_accvgpr_write_b32 a6, v20
    v_accvgpr_write_b32 a7, v22
    v_accvgpr_write_b32 a2, v24
    v_accvgpr_write_b32 a3, v26
    v_accvgpr_write_b32 a8, v28
    v_accvgpr_write_b32 a9, v30
    v_accvgpr_write_b32 a4, v32
    v_accvgpr_write_b32 a5, v34
    v_accvgpr_write_b32 a10, v36
    v_accvgpr_write_b32 a11, v38
    v_lshrrev_b32 v5, 1, v10
    v_lshlrev_b32 v5, 10, v5
    v_and_b32 v6, 1, v10
    v_lshl_add_u32 v5, v6, 9, v5
    v_lshl_add_u32 v5, v9, 4, v5
    s_lshl_b32 s4, s62, 12
    s_lshl_b32 s5, s61, 8
    s_add_u32 s4, s4, s5
    s_mul_i32 s5, s60, 28672
    s_add_u32 s5, s5, s4
    s_add_u32 s5, s5, 131072
    v_add_u32 v2, s5, v5
    s_lshl_b32 s5, s60, 6
    s_add_u32 s4, s4, s5
    v_lshl_add_u32 v5, v10, 4, s4
    v_lshl_add_u32 v5, v123, 9, v5
    v_lshrrev_b32 v6, 1, v122
    v_lshl_add_u32 v5, v6, 11, v5
    v_and_b32 v6, 1, v122
    v_lshl_add_u32 v117, v6, 3, v5
    v_add_u32 v118, 57344, v117
    s_lshl_b32 s5, s60, 3
    s_add_u32 s5, s5, s62
    s_lshl_b32 s5, s5, 1
    s_add_u32 s5, s5, s61
    s_lshl_b32 s5, s5, 7
    s_add_u32 s5, s5, 245760
    v_lshl_add_u32 v3, v9, 3, s5
    s_lshl_b32 s4, s61, 2
    s_add_u32 s4, s4, s60
    s_lshl_b32 s5, s4, 14
    v_add_u32 v4, s5, v14
    s_lshr_b32 s4, s4, 1
    s_lshl_b32 s4, s4, 9
    s_add_u32 s74, s4, 258048
    s_lshl_b32 s5, s64, 6
    s_lshl_b32 s4, s60, 2
    s_add_u32 s5, s5, s4
    v_add_u32 v5, s5, v10
    s_lshl_b32 s4, s62, 7
    v_lshl_add_u32 v6, v9, 3, s4
    s_movk_i32 s6, 896
    v_mad_u32_u24 v119, v5, s6, v6
    v_mov_b32 v8, 4048155338
    v_mov_b32 v5, 0x0c0c0c0c
    v_mov_b32 v6, 0x01000100
    v_mov_b32 v7, 0x03020302
    v_bfi_b32 v6, v13, v6, v5
    v_bfi_b32 v7, v13, v7, v5
    v_cndmask_b32 v116, v6, v5, s[92:93]
    v_cndmask_b32 v120, v7, v5, s[94:95]
    v_cndmask_b32 v121, v5, v6, s[92:93]
    v_cndmask_b32 v12, v5, v7, s[94:95]
    s_waitcnt vmcnt(6)
    v_swap_b32 v66, v68
    v_swap_b32 v67, v69
    v_swap_b32 v82, v84
    v_swap_b32 v83, v85
    v_mfma_f32_16x16x32_bf16 v[16:19], v[96:99], v[64:67], 0
    s_nop 0
    v_mfma_f32_16x16x32_bf16 v[20:23], v[80:83], v[64:67], 0
    v_mfma_f32_16x16x32_bf16 v[24:27], v[80:83], v[68:71], 0
    v_mfma_f32_16x16x32_bf16 v[28:31], v[84:87], v[68:71], 0
    v_lshl_add_u32 v5, v10, 2, v122
    v_lshlrev_b32 v6, 7, v5
    v_lshl_add_u32 v6, v123, 3, v6
    v_lshrrev_b32 v5, 1, v5
    v_and_b32 v5, 3, v5
    v_lshl_add_u32 v6, v5, 5, v6
    v_cndmask_b32 v50, v16, v17, s[90:91]
    v_cndmask_b32 v51, v18, v19, s[90:91]
    v_cndmask_b32 v48, v20, v21, s[90:91]
    v_cndmask_b32 v49, v22, v23, s[90:91]
    v_cndmask_b32 v48, v50, v48, s[92:93]
    v_cndmask_b32 v49, v51, v49, s[94:95]
    v_cndmask_b32 v48, v8, v48, s[96:97]
    v_cndmask_b32 v49, v8, v49, s[98:99]
    v_max_f32 v50, v48, v49
    s_waitcnt vmcnt(0)
    v_swap_b32 v74, v76
    v_swap_b32 v75, v77
    v_swap_b32 v90, v92
    v_swap_b32 v91, v93
    v_mfma_f32_16x16x32_bf16 v[32:35], v[100:103], v[72:75], 0
    s_nop 0
    v_mfma_f32_16x16x32_bf16 v[36:39], v[88:91], v[72:75], 0
    v_mfma_f32_16x16x32_bf16 v[40:43], v[88:91], v[76:79], 0
    v_mfma_f32_16x16x32_bf16 v[44:47], v[92:95], v[76:79], 0
    v_cndmask_b32 v54, v24, v25, s[90:91]
    v_cndmask_b32 v55, v26, v27, s[90:91]
    v_cndmask_b32 v52, v28, v29, s[90:91]
    v_cndmask_b32 v53, v30, v31, s[90:91]
    v_cndmask_b32 v52, v54, v52, s[92:93]
    v_cndmask_b32 v53, v55, v53, s[94:95]
    v_max_f32 v54, v52, v53
    v_cndmask_b32 v58, v32, v33, s[90:91]
    v_cndmask_b32 v59, v34, v35, s[90:91]
    v_cndmask_b32 v56, v36, v37, s[90:91]
    v_cndmask_b32 v57, v38, v39, s[90:91]
    v_cndmask_b32 v56, v58, v56, s[92:93]
    v_cndmask_b32 v57, v59, v57, s[94:95]
    v_cndmask_b32 v56, v8, v56, s[96:97]
    v_cndmask_b32 v57, v8, v57, s[98:99]
    v_max_f32 v58, v56, v57
    v_cndmask_b32 v62, v40, v41, s[90:91]
    v_cndmask_b32 v63, v42, v43, s[90:91]
    v_cndmask_b32 v60, v44, v45, s[90:91]
    v_cndmask_b32 v61, v46, v47, s[90:91]
    v_cndmask_b32 v60, v62, v60, s[92:93]
    v_cndmask_b32 v61, v63, v61, s[94:95]
    v_max_f32 v62, v60, v61
    v_permlane16_swap_b32 v50, v54
    v_xor_b32 v92, 0, v6
    v_permlane16_swap_b32 v58, v62
    v_max_f32 v50, v50, v54
    v_max_f32 v58, v58, v62
    v_xor_b32 v93, 32, v6
    v_xor_b32 v94, 64, v6
    v_permlane32_swap_b32 v50, v58
    v_max_f32 v50, v50, v58
    v_mov_b32 v58, v50
    v_xor_b32 v95, 96, v6
    v_lshrrev_b32 v5, 1, v10
    v_permlane32_swap_b32 v50, v58
    v_mov_b32 v54, v50
    v_mov_b32 v62, v58
    v_lshl_add_u32 v5, v5, 2, v122
    v_permlane16_swap_b32 v50, v54
    v_permlane16_swap_b32 v58, v62
    v_pk_add_f32 v[48:49], v[48:49], v[50:51] op_sel_hi:[1,0] neg_lo:[0,1] neg_hi:[0,1]
    v_pk_add_f32 v[52:53], v[52:53], v[54:55] op_sel_hi:[1,0] neg_lo:[0,1] neg_hi:[0,1]
    v_pk_add_f32 v[56:57], v[56:57], v[58:59] op_sel_hi:[1,0] neg_lo:[0,1] neg_hi:[0,1]
    v_pk_add_f32 v[60:61], v[60:61], v[62:63] op_sel_hi:[1,0] neg_lo:[0,1] neg_hi:[0,1]
    v_exp_f32 v48, v48
    v_exp_f32 v49, v49
    v_exp_f32 v52, v52
    s_branch Lsk4
Lstub4:
    s_setpc_b64 s[28:29]
Lsk4:
    v_exp_f32 v53, v53
    v_exp_f32 v56, v56
    v_exp_f32 v57, v57
    v_exp_f32 v60, v60
    v_exp_f32 v61, v61
    v_add_f32 v50, v48, v49
    v_add_f32 v54, v52, v53
    v_add_f32 v58, v56, v57
    v_add_f32 v62, v60, v61
    v_permlane16_swap_b32 v50, v54
    v_lshlrev_b32 v5, 8, v5
    v_permlane16_swap_b32 v58, v62
    v_add_f32 v50, v50, v54
    v_add_f32 v58, v58, v62
    v_xor_b32 v6, s60, v122
    v_lshl_add_u32 v5, v6, 6, v5
    v_permlane32_swap_b32 v50, v58
    v_add_f32 v50, v50, v58
    v_rcp_f32 v50, v50
    v_and_b32 v6, 1, v10
    v_mov_b32 v58, v50
    v_lshl_add_u32 v5, v6, 5, v5
    v_lshl_add_u32 v5, v123, 3, v5
    v_permlane32_swap_b32 v50, v58
    v_mov_b32 v54, v50
    v_mov_b32 v62, v58
    v_add_u32 v88, 65536, v5
    v_permlane16_swap_b32 v50, v54
    v_permlane16_swap_b32 v58, v62
    v_pk_mul_f32 v[48:49], v[48:49], v[50:51] op_sel_hi:[1,0]
    v_pk_mul_f32 v[52:53], v[52:53], v[54:55] op_sel_hi:[1,0]
    v_pk_mul_f32 v[56:57], v[56:57], v[58:59] op_sel_hi:[1,0]
    v_pk_mul_f32 v[60:61], v[60:61], v[62:63] op_sel_hi:[1,0]
    v_cvt_pk_bf16_f32 v48, v48, v49
    v_cvt_pk_bf16_f32 v52, v52, v53
    v_cvt_pk_bf16_f32 v56, v56, v57
    v_cvt_pk_bf16_f32 v60, v60, v61
    v_perm_b32 v64, v48, v48, v116
    v_perm_b32 v65, v48, v48, v120
    v_perm_b32 v66, v48, v48, v121
    v_perm_b32 v67, v48, v48, v12
    v_perm_b32 v72, v56, v56, v116
    v_perm_b32 v73, v56, v56, v120
    v_perm_b32 v74, v56, v56, v121
    v_perm_b32 v75, v56, v56, v12
    v_mfma_f32_16x16x32_bf16 v[16:19], v[104:107], v[64:67], 0
    v_mfma_f32_16x16x32_bf16 v[20:23], v[110:113], v[64:67], 0
    v_mfma_f32_16x16x32_bf16 v[16:19], a[0:3], v[72:75], v[16:19]
    v_mfma_f32_16x16x32_bf16 v[20:23], a[6:9], v[72:75], v[20:23]
    v_perm_b32 v68, v52, v52, v116
    v_perm_b32 v69, v52, v52, v120
    v_perm_b32 v70, v52, v52, v121
    v_perm_b32 v71, v52, v52, v12
    v_perm_b32 v76, v60, v60, v116
    v_perm_b32 v77, v60, v60, v120
    v_perm_b32 v78, v60, v60, v121
    v_perm_b32 v79, v60, v60, v12
    v_mfma_f32_16x16x32_bf16 v[24:27], v[106:109], v[68:71], 0
    v_mfma_f32_16x16x32_bf16 v[28:31], v[112:115], v[68:71], 0
    v_mfma_f32_16x16x32_bf16 v[24:27], a[2:5], v[76:79], v[24:27]
    v_mfma_f32_16x16x32_bf16 v[28:31], a[8:11], v[76:79], v[28:31]
    s_cmp_lg_u32 s69, 0
    s_cselect_b64 vcc, -1, 0
    v_add_u32 v89, 114688, v5
    v_cvt_pk_bf16_f32 v80, v16, v17
    v_cvt_pk_bf16_f32 v81, v18, v19
    v_cvt_pk_bf16_f32 v82, v20, v21
    v_cvt_pk_bf16_f32 v83, v22, v23
    v_min_u32 v80, -2, v80
    s_cbranch_vccz Lds0
    buffer_store_dwordx4 v[80:83], v14, s[56:59], s79 offen
Ldd0:
    v_cvt_pk_bf16_f32 v84, v24, v25
    v_cvt_pk_bf16_f32 v85, v26, v27
    v_cvt_pk_bf16_f32 v86, v28, v29
    v_cvt_pk_bf16_f32 v87, v30, v31
    v_min_u32 v84, -2, v84
    s_cbranch_vccz Lds1
    buffer_store_dwordx4 v[84:87], v14, s[56:59], s80 offen
Ldd1:
    v_accvgpr_read_b32 v97, a116
    v_accvgpr_read_b32 v99, a117
    v_accvgpr_read_b32 v101, a118
    v_accvgpr_read_b32 v103, a119
    v_accvgpr_read_b32 v105, a120
    v_accvgpr_read_b32 v107, a121
    v_accvgpr_read_b32 v109, a122
    v_accvgpr_read_b32 v111, a123
    v_accvgpr_read_b32 v113, a114
    v_accvgpr_read_b32 v115, a115
    v_accvgpr_read_b32 v116, a112
    v_lshlrev_b32 v96, 16, v97
    v_and_b32 v97, 0xffff0000, v97
    v_lshlrev_b32 v98, 16, v99
    v_and_b32 v99, 0xffff0000, v99
    v_lshlrev_b32 v100, 16, v101
    v_and_b32 v101, 0xffff0000, v101
    v_lshlrev_b32 v102, 16, v103
    v_and_b32 v103, 0xffff0000, v103
    v_lshlrev_b32 v104, 16, v105
    v_and_b32 v105, 0xffff0000, v105
    v_lshlrev_b32 v106, 16, v107
    v_and_b32 v107, 0xffff0000, v107
    v_lshlrev_b32 v108, 16, v109
    v_and_b32 v109, 0xffff0000, v109
    v_lshlrev_b32 v110, 16, v111
    v_and_b32 v111, 0xffff0000, v111
    v_lshlrev_b32 v112, 16, v113
    v_and_b32 v113, 0xffff0000, v113
    v_lshlrev_b32 v114, 16, v115
    v_and_b32 v115, 0xffff0000, v115
    s_barrier
    s_movk_i32 s37, 4096
    s_movk_i32 s38, 8192
    s_movk_i32 s39, 12288
    s_mov_b32 s40, 0
    buffer_load_dwordx4 v[16:19], v4, s[56:59], 0 offen offset:0 sc1
    buffer_load_dwordx4 v[20:23], v4, s[56:59], 0 offen offset:1024 sc1
    buffer_load_dwordx4 v[24:27], v4, s[56:59], 0 offen offset:2048 sc1
    buffer_load_dwordx4 v[28:31], v4, s[56:59], 0 offen offset:3072 sc1
    buffer_load_dwordx4 v[32:35], v4, s[56:59], s37 offen offset:0 sc1
    ds_read_b64_tr_b16 a[64:65], v92 offset:0
    ds_read_b64_tr_b16 a[66:67], v92 offset:2048
    ds_read_b64_tr_b16 a[68:69], v93 offset:0
    ds_read_b64_tr_b16 a[70:71], v93 offset:2048
    ds_read_b64_tr_b16 a[72:73], v94 offset:0
    ds_read_b64_tr_b16 a[74:75], v94 offset:2048
    ds_read_b64_tr_b16 a[76:77], v95 offset:0
    buffer_load_dwordx4 v[36:39], v4, s[56:59], s37 offen offset:1024 sc1
    ds_read_b64_tr_b16 a[78:79], v95 offset:2048
    ds_read_b64_tr_b16 a[80:81], v92 offset:4096
    ds_read_b64_tr_b16 a[82:83], v92 offset:6144
    ds_read_b64_tr_b16 a[84:85], v93 offset:4096
    ds_read_b64_tr_b16 a[86:87], v93 offset:6144
    ds_read_b64_tr_b16 a[88:89], v94 offset:4096
    ds_read_b64_tr_b16 a[90:91], v94 offset:6144
    buffer_load_dwordx4 v[40:43], v4, s[56:59], s37 offen offset:2048 sc1
    ds_read_b64_tr_b16 a[92:93], v95 offset:4096
    ds_read_b64_tr_b16 a[94:95], v95 offset:6144
    ds_read_b64_tr_b16 a[96:97], v92 offset:8192
    ds_read_b64_tr_b16 a[98:99], v92 offset:10240
    ds_read_b64_tr_b16 a[100:101], v93 offset:8192
    ds_read_b64_tr_b16 a[102:103], v93 offset:10240
    ds_read_b64_tr_b16 a[104:105], v94 offset:8192
    buffer_load_dwordx4 v[44:47], v4, s[56:59], s37 offen offset:3072 sc1
    ds_read_b64_tr_b16 a[106:107], v94 offset:10240
    ds_read_b64_tr_b16 a[108:109], v95 offset:8192
    ds_read_b64_tr_b16 a[110:111], v95 offset:10240
    ds_read_b64_tr_b16 a[0:1], v89 offset:32768
    ds_read_b64_tr_b16 a[2:3], v89 offset:36864
    ds_read_b64_tr_b16 a[4:5], v89 offset:34816
    ds_read_b64_tr_b16 a[6:7], v89 offset:38912
    buffer_load_dwordx4 v[48:51], v4, s[56:59], s38 offen offset:0 sc1
    ds_read_b64_tr_b16 a[8:9], v89 offset:40960
    ds_read_b64_tr_b16 a[10:11], v89 offset:45056
    ds_read_b64_tr_b16 a[12:13], v89 offset:43008
    ds_read_b64_tr_b16 a[14:15], v89 offset:47104
    ds_read_b64_tr_b16 a[16:17], v89 offset:16384
    ds_read_b64_tr_b16 a[18:19], v89 offset:20480
    ds_read_b64_tr_b16 a[20:21], v89 offset:18432
    buffer_load_dwordx4 v[52:55], v4, s[56:59], s38 offen offset:1024 sc1
    ds_read_b64_tr_b16 a[22:23], v89 offset:22528
    ds_read_b64_tr_b16 a[24:25], v89 offset:24576
    ds_read_b64_tr_b16 a[26:27], v89 offset:28672
    ds_read_b64_tr_b16 a[28:29], v89 offset:26624
    ds_read_b64_tr_b16 a[30:31], v89 offset:30720
    ds_read_b64_tr_b16 a[32:33], v89 offset:0
    ds_read_b64_tr_b16 a[34:35], v89 offset:4096
    buffer_load_dwordx4 v[56:59], v4, s[56:59], s38 offen offset:2048 sc1
    ds_read_b64_tr_b16 a[36:37], v89 offset:2048
    ds_read_b64_tr_b16 a[38:39], v89 offset:6144
    ds_read_b64_tr_b16 a[40:41], v89 offset:8192
    ds_read_b64_tr_b16 a[42:43], v89 offset:12288
    ds_read_b64_tr_b16 a[44:45], v89 offset:10240
    ds_read_b64_tr_b16 a[46:47], v89 offset:14336
    ds_read_b64_tr_b16 a[48:49], v88 offset:32768
    buffer_load_dwordx4 v[60:63], v4, s[56:59], s38 offen offset:3072 sc1
    ds_read_b64_tr_b16 a[50:51], v88 offset:36864
    ds_read_b64_tr_b16 a[52:53], v88 offset:34816
    ds_read_b64_tr_b16 a[54:55], v88 offset:38912
    ds_read_b64_tr_b16 a[56:57], v88 offset:40960
    ds_read_b64_tr_b16 a[58:59], v88 offset:45056
    ds_read_b64_tr_b16 a[60:61], v88 offset:43008
    ds_read_b64_tr_b16 a[62:63], v88 offset:47104
    buffer_load_dwordx4 v[64:67], v4, s[56:59], s39 offen offset:0 sc1
    buffer_load_dwordx4 v[68:71], v4, s[56:59], s39 offen offset:1024 sc1
    s_waitcnt lgkmcnt(0)
    s_lshl_b32 s4, s60, 7
    s_add_u32 s4, s4, s71
    s_lshl_b32 s4, s4, 2
    s_add_u32 s4, s4, 260096
    v_add_u32 v11, s4, v124
    s_cmp_lg_u32 s69, 0
    s_cselect_b64 vcc, -1, 0
    s_branch Lov
Lor:
    v_max_u32 v72, v16, v20
    v_cmp_eq_u32 s[4:5], -1, v72
    s_nop 0
    s_cmp_eq_u64 s[4:5], 0
    s_cbranch_scc1 Los0
    buffer_load_dwordx4 v[16:19], v4, s[56:59], 0 offen offset:0 sc1
    buffer_load_dwordx4 v[20:23], v4, s[56:59], 0 offen offset:1024 sc1
Los0:
    v_max_u32 v72, v24, v28
    v_cmp_eq_u32 s[4:5], -1, v72
    s_nop 0
    s_cmp_eq_u64 s[4:5], 0
    s_cbranch_scc1 Los2
    buffer_load_dwordx4 v[24:27], v4, s[56:59], 0 offen offset:2048 sc1
    buffer_load_dwordx4 v[28:31], v4, s[56:59], 0 offen offset:3072 sc1
Los2:
    v_max_u32 v72, v32, v36
    v_cmp_eq_u32 s[4:5], -1, v72
    s_nop 0
    s_cmp_eq_u64 s[4:5], 0
    s_cbranch_scc1 Los4
    buffer_load_dwordx4 v[32:35], v4, s[56:59], s37 offen offset:0 sc1
    buffer_load_dwordx4 v[36:39], v4, s[56:59], s37 offen offset:1024 sc1
Los4:
    v_max_u32 v72, v40, v44
    v_cmp_eq_u32 s[4:5], -1, v72
    s_nop 0
    s_cmp_eq_u64 s[4:5], 0
    s_cbranch_scc1 Los6
    buffer_load_dwordx4 v[40:43], v4, s[56:59], s37 offen offset:2048 sc1
    buffer_load_dwordx4 v[44:47], v4, s[56:59], s37 offen offset:3072 sc1
Los6:
    v_max_u32 v72, v48, v52
    v_cmp_eq_u32 s[4:5], -1, v72
    s_nop 0
    s_cmp_eq_u64 s[4:5], 0
    s_cbranch_scc1 Los8
    buffer_load_dwordx4 v[48:51], v4, s[56:59], s38 offen offset:0 sc1
    buffer_load_dwordx4 v[52:55], v4, s[56:59], s38 offen offset:1024 sc1
Los8:
    v_max_u32 v72, v56, v60
    v_cmp_eq_u32 s[4:5], -1, v72
    s_nop 0
    s_cmp_eq_u64 s[4:5], 0
    s_cbranch_scc1 Los10
    buffer_load_dwordx4 v[56:59], v4, s[56:59], s38 offen offset:2048 sc1
    buffer_load_dwordx4 v[60:63], v4, s[56:59], s38 offen offset:3072 sc1
Los10:
    v_max_u32 v72, v64, v68
    v_cmp_eq_u32 s[4:5], -1, v72
    s_nop 0
    s_cmp_eq_u64 s[4:5], 0
    s_cbranch_scc1 Los12
    buffer_load_dwordx4 v[64:67], v4, s[56:59], s39 offen offset:0 sc1
    buffer_load_dwordx4 v[68:71], v4, s[56:59], s39 offen offset:1024 sc1
Los12:
    s_add_u32 s40, s40, 1
    s_cmp_gt_u32 s40, 0x800000
    s_cbranch_scc1 Lend
Lov:
    s_waitcnt vmcnt(0)
    v_max3_u32 v72, v16, v20, v24
    v_max3_u32 v73, v28, v32, v36
    v_max3_u32 v74, v40, v44, v48
    v_max3_u32 v75, v52, v56, v60
    v_max3_u32 v76, v64, v68, v72
    v_max3_u32 v77, v73, v74, v75
    v_max_u32 v78, v76, v77
    v_cmp_eq_u32 s[4:5], -1, v78
    s_nop 0
    s_cmp_lg_u64 s[4:5], 0
    s_cbranch_scc1 Lor
    s_barrier
    v_mfma_f32_16x16x32_bf16 v[96:99], a[64:67], v[16:19], v[96:99]
    ds_read_b64_tr_b16 a[112:113], v92 offset:12288
    ds_read_b64_tr_b16 a[114:115], v92 offset:14336
    v_mfma_f32_16x16x32_bf16 v[100:103], a[68:71], v[16:19], v[100:103]
    ds_read_b64_tr_b16 a[116:117], v93 offset:12288
    ds_read_b64_tr_b16 a[118:119], v93 offset:14336
    v_mfma_f32_16x16x32_bf16 v[104:107], a[72:75], v[16:19], v[104:107]
    ds_read_b64_tr_b16 a[120:121], v94 offset:12288
    ds_read_b64_tr_b16 a[122:123], v94 offset:14336
    v_mfma_f32_16x16x32_bf16 v[108:111], a[76:79], v[16:19], v[108:111]
    ds_read_b64_tr_b16 a[124:125], v95 offset:12288
    ds_read_b64_tr_b16 a[126:127], v95 offset:14336
    v_mfma_f32_16x16x32_bf16 v[96:99], a[80:83], v[20:23], v[96:99]
    ds_read_b64_tr_b16 a[64:65], v92 offset:16384
    ds_read_b64_tr_b16 a[66:67], v92 offset:18432
    v_mfma_f32_16x16x32_bf16 v[100:103], a[84:87], v[20:23], v[100:103]
    ds_read_b64_tr_b16 a[68:69], v93 offset:16384
    ds_read_b64_tr_b16 a[70:71], v93 offset:18432
    v_mfma_f32_16x16x32_bf16 v[104:107], a[88:91], v[20:23], v[104:107]
    ds_read_b64_tr_b16 a[72:73], v94 offset:16384
    ds_read_b64_tr_b16 a[74:75], v94 offset:18432
    v_mfma_f32_16x16x32_bf16 v[108:111], a[92:95], v[20:23], v[108:111]
    ds_read_b64_tr_b16 a[76:77], v95 offset:16384
    ds_read_b64_tr_b16 a[78:79], v95 offset:18432
    v_mfma_f32_16x16x32_bf16 v[96:99], a[96:99], v[24:27], v[96:99]
    ds_read_b64_tr_b16 a[80:81], v92 offset:20480
    ds_read_b64_tr_b16 a[82:83], v92 offset:22528
    v_mfma_f32_16x16x32_bf16 v[100:103], a[100:103], v[24:27], v[100:103]
    ds_read_b64_tr_b16 a[84:85], v93 offset:20480
    ds_read_b64_tr_b16 a[86:87], v93 offset:22528
    v_mfma_f32_16x16x32_bf16 v[104:107], a[104:107], v[24:27], v[104:107]
    ds_read_b64_tr_b16 a[88:89], v94 offset:20480
    ds_read_b64_tr_b16 a[90:91], v94 offset:22528
    v_mfma_f32_16x16x32_bf16 v[108:111], a[108:111], v[24:27], v[108:111]
    ds_read_b64_tr_b16 a[92:93], v95 offset:20480
    ds_read_b64_tr_b16 a[94:95], v95 offset:22528
    s_waitcnt lgkmcnt(15)
    v_mfma_f32_16x16x32_bf16 v[96:99], a[112:115], v[28:31], v[96:99]
    ds_read_b64_tr_b16 a[96:97], v92 offset:24576
    ds_read_b64_tr_b16 a[98:99], v92 offset:26624
    v_mfma_f32_16x16x32_bf16 v[100:103], a[116:119], v[28:31], v[100:103]
    ds_read_b64_tr_b16 a[100:101], v93 offset:24576
    ds_read_b64_tr_b16 a[102:103], v93 offset:26624
    v_mfma_f32_16x16x32_bf16 v[104:107], a[120:123], v[28:31], v[104:107]
    ds_read_b64_tr_b16 a[104:105], v94 offset:24576
    ds_read_b64_tr_b16 a[106:107], v94 offset:26624
    v_mfma_f32_16x16x32_bf16 v[108:111], a[124:127], v[28:31], v[108:111]
    ds_read_b64_tr_b16 a[108:109], v95 offset:24576
    ds_read_b64_tr_b16 a[110:111], v95 offset:26624
    s_waitcnt lgkmcnt(15)
    v_mfma_f32_16x16x32_bf16 v[96:99], a[64:67], v[32:35], v[96:99]
    ds_read_b64_tr_b16 a[112:113], v92 offset:28672
    ds_read_b64_tr_b16 a[114:115], v92 offset:30720
    v_mfma_f32_16x16x32_bf16 v[100:103], a[68:71], v[32:35], v[100:103]
    ds_read_b64_tr_b16 a[116:117], v93 offset:28672
    ds_read_b64_tr_b16 a[118:119], v93 offset:30720
    v_mfma_f32_16x16x32_bf16 v[104:107], a[72:75], v[32:35], v[104:107]
    ds_read_b64_tr_b16 a[120:121], v94 offset:28672
    ds_read_b64_tr_b16 a[122:123], v94 offset:30720
    v_mfma_f32_16x16x32_bf16 v[108:111], a[76:79], v[32:35], v[108:111]
    ds_read_b64_tr_b16 a[124:125], v95 offset:28672
    ds_read_b64_tr_b16 a[126:127], v95 offset:30720
    s_waitcnt lgkmcnt(15)
    v_mfma_f32_16x16x32_bf16 v[96:99], a[80:83], v[36:39], v[96:99]
    ds_read_b64_tr_b16 a[64:65], v92 offset:32768
    ds_read_b64_tr_b16 a[66:67], v92 offset:34816
    v_mfma_f32_16x16x32_bf16 v[100:103], a[84:87], v[36:39], v[100:103]
    ds_read_b64_tr_b16 a[68:69], v93 offset:32768
    ds_read_b64_tr_b16 a[70:71], v93 offset:34816
    v_mfma_f32_16x16x32_bf16 v[104:107], a[88:91], v[36:39], v[104:107]
    ds_read_b64_tr_b16 a[72:73], v94 offset:32768
    ds_read_b64_tr_b16 a[74:75], v94 offset:34816
    v_mfma_f32_16x16x32_bf16 v[108:111], a[92:95], v[36:39], v[108:111]
    ds_read_b64_tr_b16 a[76:77], v95 offset:32768
    ds_read_b64_tr_b16 a[78:79], v95 offset:34816
    s_waitcnt lgkmcnt(15)
    v_mfma_f32_16x16x32_bf16 v[96:99], a[96:99], v[40:43], v[96:99]
    ds_read_b64_tr_b16 a[80:81], v92 offset:36864
    ds_read_b64_tr_b16 a[82:83], v92 offset:38912
    v_mfma_f32_16x16x32_bf16 v[100:103], a[100:103], v[40:43], v[100:103]
    ds_read_b64_tr_b16 a[84:85], v93 offset:36864
    ds_read_b64_tr_b16 a[86:87], v93 offset:38912
    v_mfma_f32_16x16x32_bf16 v[104:107], a[104:107], v[40:43], v[104:107]
    ds_read_b64_tr_b16 a[88:89], v94 offset:36864
    ds_read_b64_tr_b16 a[90:91], v94 offset:38912
    v_mfma_f32_16x16x32_bf16 v[108:111], a[108:111], v[40:43], v[108:111]
    ds_read_b64_tr_b16 a[92:93], v95 offset:36864
    ds_read_b64_tr_b16 a[94:95], v95 offset:38912
    s_waitcnt lgkmcnt(15)
    v_mfma_f32_16x16x32_bf16 v[96:99], a[112:115], v[44:47], v[96:99]
    ds_read_b64_tr_b16 a[96:97], v92 offset:40960
    ds_read_b64_tr_b16 a[98:99], v92 offset:43008
    v_mfma_f32_16x16x32_bf16 v[100:103], a[116:119], v[44:47], v[100:103]
    ds_read_b64_tr_b16 a[100:101], v93 offset:40960
    ds_read_b64_tr_b16 a[102:103], v93 offset:43008
    v_mfma_f32_16x16x32_bf16 v[104:107], a[120:123], v[44:47], v[104:107]
    ds_read_b64_tr_b16 a[104:105], v94 offset:40960
    ds_read_b64_tr_b16 a[106:107], v94 offset:43008
    v_mfma_f32_16x16x32_bf16 v[108:111], a[124:127], v[44:47], v[108:111]
    ds_read_b64_tr_b16 a[108:109], v95 offset:40960
    ds_read_b64_tr_b16 a[110:111], v95 offset:43008
    s_waitcnt lgkmcnt(15)
    v_mfma_f32_16x16x32_bf16 v[96:99], a[64:67], v[48:51], v[96:99]
    ds_read_b64_tr_b16 a[112:113], v92 offset:45056
    ds_read_b64_tr_b16 a[114:115], v92 offset:47104
    v_mfma_f32_16x16x32_bf16 v[100:103], a[68:71], v[48:51], v[100:103]
    ds_read_b64_tr_b16 a[116:117], v93 offset:45056
    ds_read_b64_tr_b16 a[118:119], v93 offset:47104
    v_mfma_f32_16x16x32_bf16 v[104:107], a[72:75], v[48:51], v[104:107]
    ds_read_b64_tr_b16 a[120:121], v94 offset:45056
    ds_read_b64_tr_b16 a[122:123], v94 offset:47104
    v_mfma_f32_16x16x32_bf16 v[108:111], a[76:79], v[48:51], v[108:111]
    ds_read_b64_tr_b16 a[124:125], v95 offset:45056
    ds_read_b64_tr_b16 a[126:127], v95 offset:47104
    s_waitcnt lgkmcnt(15)
    v_mfma_f32_16x16x32_bf16 v[96:99], a[80:83], v[52:55], v[96:99]
    ds_read_b64_tr_b16 a[64:65], v92 offset:49152
    ds_read_b64_tr_b16 a[66:67], v92 offset:51200
    v_mfma_f32_16x16x32_bf16 v[100:103], a[84:87], v[52:55], v[100:103]
    ds_read_b64_tr_b16 a[68:69], v93 offset:49152
    ds_read_b64_tr_b16 a[70:71], v93 offset:51200
    v_mfma_f32_16x16x32_bf16 v[104:107], a[88:91], v[52:55], v[104:107]
    ds_read_b64_tr_b16 a[72:73], v94 offset:49152
    ds_read_b64_tr_b16 a[74:75], v94 offset:51200
    v_mfma_f32_16x16x32_bf16 v[108:111], a[92:95], v[52:55], v[108:111]
    ds_read_b64_tr_b16 a[76:77], v95 offset:49152
    ds_read_b64_tr_b16 a[78:79], v95 offset:51200
    s_waitcnt lgkmcnt(15)
    v_mfma_f32_16x16x32_bf16 v[96:99], a[96:99], v[56:59], v[96:99]
    ds_read_b64_tr_b16 a[80:81], v92 offset:53248
    ds_read_b64_tr_b16 a[82:83], v92 offset:55296
    v_mfma_f32_16x16x32_bf16 v[100:103], a[100:103], v[56:59], v[100:103]
    ds_read_b64_tr_b16 a[84:85], v93 offset:53248
    ds_read_b64_tr_b16 a[86:87], v93 offset:55296
    v_mfma_f32_16x16x32_bf16 v[104:107], a[104:107], v[56:59], v[104:107]
    ds_read_b64_tr_b16 a[88:89], v94 offset:53248
    ds_read_b64_tr_b16 a[90:91], v94 offset:55296
    v_mfma_f32_16x16x32_bf16 v[108:111], a[108:111], v[56:59], v[108:111]
    ds_read_b64_tr_b16 a[92:93], v95 offset:53248
    ds_read_b64_tr_b16 a[94:95], v95 offset:55296
    s_waitcnt lgkmcnt(15)
    v_mfma_f32_16x16x32_bf16 v[96:99], a[112:115], v[60:63], v[96:99]
    v_mfma_f32_16x16x32_bf16 v[100:103], a[116:119], v[60:63], v[100:103]
    v_mfma_f32_16x16x32_bf16 v[104:107], a[120:123], v[60:63], v[104:107]
    v_mfma_f32_16x16x32_bf16 v[108:111], a[124:127], v[60:63], v[108:111]
    s_waitcnt lgkmcnt(8)
    v_mfma_f32_16x16x32_bf16 v[96:99], a[64:67], v[64:67], v[96:99]
    v_mfma_f32_16x16x32_bf16 v[100:103], a[68:71], v[64:67], v[100:103]
    v_mfma_f32_16x16x32_bf16 v[104:107], a[72:75], v[64:67], v[104:107]
    v_mfma_f32_16x16x32_bf16 v[108:111], a[76:79], v[64:67], v[108:111]
    s_waitcnt lgkmcnt(0)
    v_mfma_f32_16x16x32_bf16 v[96:99], a[80:83], v[68:71], v[96:99]
    v_mfma_f32_16x16x32_bf16 v[100:103], a[84:87], v[68:71], v[100:103]
    v_mfma_f32_16x16x32_bf16 v[104:107], a[88:91], v[68:71], v[104:107]
    v_mfma_f32_16x16x32_bf16 v[108:111], a[92:95], v[68:71], v[108:111]
    v_mov_b32 v20, 0x3f803f80
    s_nop 3
    v_cvt_pk_bf16_f32 v80, v96, v97
    v_cvt_pk_bf16_f32 v81, v98, v99
    v_cvt_pk_bf16_f32 v82, v100, v101
    v_cvt_pk_bf16_f32 v83, v102, v103
    buffer_store_dwordx4 v[80:83], v2, s[56:59], 0 offen offset:0 sc1
    v_cvt_pk_bf16_f32 v84, v104, v105
    v_cvt_pk_bf16_f32 v85, v106, v107
    v_cvt_pk_bf16_f32 v86, v108, v109
    v_cvt_pk_bf16_f32 v87, v110, v111
    buffer_store_dwordx4 v[84:87], v2, s[56:59], 0 offen offset:2048 sc1
    v_dot2_f32_bf16 v16, v80, v20, 0
    v_dot2_f32_bf16 v17, v80, v80, 0
    v_dot2_f32_bf16 v16, v81, v20, v16
    v_dot2_f32_bf16 v17, v81, v81, v17
    v_dot2_f32_bf16 v16, v82, v20, v16
    v_dot2_f32_bf16 v17, v82, v82, v17
    v_dot2_f32_bf16 v16, v83, v20, v16
    v_dot2_f32_bf16 v17, v83, v83, v17
    v_dot2_f32_bf16 v16, v84, v20, v16
    v_dot2_f32_bf16 v17, v84, v84, v17
    v_dot2_f32_bf16 v16, v85, v20, v16
    v_dot2_f32_bf16 v17, v85, v85, v17
    v_dot2_f32_bf16 v16, v86, v20, v16
    v_dot2_f32_bf16 v17, v86, v86, v17
    v_dot2_f32_bf16 v16, v87, v20, v16
    v_dot2_f32_bf16 v17, v87, v87, v17
    s_nop 2
    v_permlane16_swap_b32 v16, v17
    v_add_f32 v16, v16, v17
    v_mov_b32 v17, v16
    s_nop 1
    v_permlane32_swap_b32 v16, v17
    v_add_f32 v16, v16, v17
    v_mov_b32 v17, v16
    s_nop 1
    v_permlane16_swap_b32 v16, v17
    s_mov_b64 exec, 0xffff
    buffer_store_dwordx2 v[16:17], v3, s[56:59], 0 offen sc1
    s_mov_b64 exec, -1
    s_barrier
    ds_read_b64_tr_b16 a[64:65], v88 offset:16384
    ds_read_b64_tr_b16 a[66:67], v88 offset:20480
    ds_read_b64_tr_b16 a[68:69], v88 offset:18432
    ds_read_b64_tr_b16 a[70:71], v88 offset:22528
    ds_read_b64_tr_b16 a[72:73], v88 offset:24576
    ds_read_b64_tr_b16 a[74:75], v88 offset:28672
    ds_read_b64_tr_b16 a[76:77], v88 offset:26624
    ds_read_b64_tr_b16 a[78:79], v88 offset:30720
    ds_read_b64_tr_b16 a[80:81], v88 offset:0
    ds_read_b64_tr_b16 a[82:83], v88 offset:4096
    ds_read_b64_tr_b16 a[84:85], v88 offset:2048
    ds_read_b64_tr_b16 a[86:87], v88 offset:6144
    ds_read_b64_tr_b16 a[88:89], v88 offset:8192
    ds_read_b64_tr_b16 a[90:91], v88 offset:12288
    ds_read_b64_tr_b16 a[92:93], v88 offset:10240
    ds_read_b64_tr_b16 a[94:95], v88 offset:14336
    ds_read_b64_tr_b16 a[96:97], v88 offset:32768
    ds_read_b64_tr_b16 a[98:99], v88 offset:36864
    ds_read_b64_tr_b16 a[100:101], v88 offset:34816
    ds_read_b64_tr_b16 a[102:103], v88 offset:38912
    ds_read_b64_tr_b16 a[104:105], v88 offset:40960
    ds_read_b64_tr_b16 a[106:107], v88 offset:45056
    ds_read_b64_tr_b16 a[108:109], v88 offset:43008
    ds_read_b64_tr_b16 a[110:111], v88 offset:47104
    v_lshrrev_b32 v5, 2, v0
    v_xor_b32 v5, v5, v10
    v_and_b32 v5, 1, v5
    v_cmp_eq_u32 vcc, 0, v5
    s_nop 1
    v_cndmask_b32 v24, 0, v20, vcc
    v_cndmask_b32 v25, 0, v20, vcc
    v_cndmask_b32 v26, 0, v20, vcc
    v_cndmask_b32 v27, 0, v20, vcc
    s_nop 1
    v_mfma_f32_16x16x32_bf16 v[28:31], v[24:27], a[0:3], 0
    v_add_u32 v88, 57344, v14
    v_and_b32 v5, 31, v0
    v_mfma_f32_16x16x32_bf16 v[28:31], v[24:27], a[4:7], v[28:31]
    v_lshlrev_b32 v5, 3, v5
    v_lshrrev_b32 v6, 5, v0
    v_mfma_f32_16x16x32_bf16 v[28:31], v[24:27], a[8:11], v[28:31]
    v_lshl_add_u32 v5, v6, 11, v5
    v_add_u32 v89, 114688, v5
    v_mfma_f32_16x16x32_bf16 v[28:31], v[24:27], a[12:15], v[28:31]
    s_lshl_b32 s4, s60, 6
    v_lshl_add_u32 v5, v10, 4, s4
    v_mfma_f32_16x16x32_bf16 v[28:31], v[24:27], a[16:19], v[28:31]
    v_mul_u32_u24 v6, 272, v9
    v_add_u32 v125, v5, v6
    v_mfma_f32_16x16x32_bf16 v[28:31], v[24:27], a[20:23], v[28:31]
    v_and_b32 v5, 1, v10
    v_mul_u32_u24 v5, 229376, v5
    v_mfma_f32_16x16x32_bf16 v[28:31], v[24:27], a[24:27], v[28:31]
    v_lshrrev_b32 v6, 1, v10
    v_lshl_add_u32 v6, v6, 4, v9
    v_mfma_f32_16x16x32_bf16 v[28:31], v[24:27], a[28:31], v[28:31]
    v_lshl_add_u32 v12, v6, 4, v5
    s_lshl_b32 s7, s71, 2
    v_mfma_f32_16x16x32_bf16 v[28:31], v[24:27], a[32:35], v[28:31]
    s_add_u32 s7, s7, s60
    s_lshl_b32 s4, s7, 10
    v_mfma_f32_16x16x32_bf16 v[28:31], v[24:27], a[36:39], v[28:31]
    s_add_u32 s4, s4, 262144
    v_add_u32 v12, s4, v12
    v_mfma_f32_16x16x32_bf16 v[28:31], v[24:27], a[40:43], v[28:31]
    s_mul_i32 s79, s60, 7168
    s_mov_b32 s76, -1
    v_mfma_f32_16x16x32_bf16 v[28:31], v[24:27], a[44:47], v[28:31]
    s_mov_b32 s77, 0
    s_mov_b32 s74, 260096
    v_mfma_f32_16x16x32_bf16 v[28:31], v[24:27], a[48:51], v[28:31]
    s_mul_i32 s4, s7, 37
    s_lshr_b32 s4, s4, 9
    v_mfma_f32_16x16x32_bf16 v[28:31], v[24:27], a[52:55], v[28:31]
    s_mul_i32 s5, s4, 14
    s_sub_u32 s5, s7, s5
    v_mfma_f32_16x16x32_bf16 v[28:31], v[24:27], a[56:59], v[28:31]
    s_lshl_b32 s5, s5, 2
    s_lshl_b32 s4, s4, 8
    v_mfma_f32_16x16x32_bf16 v[28:31], v[24:27], a[60:63], v[28:31]
    s_add_u32 s4, s4, s5
    s_add_u32 s4, s4, 253952
    s_waitcnt lgkmcnt(0)
    v_mfma_f32_16x16x32_bf16 v[28:31], v[24:27], a[64:67], v[28:31]
    v_lshl_add_u32 v5, v0, 6, s4
    v_mov_b32 v6, 2147483632
    v_mfma_f32_16x16x32_bf16 v[28:31], v[24:27], a[68:71], v[28:31]
    v_cmp_gt_u32 vcc, 4, v0
    s_nop 1
    v_cndmask_b32 v90, v6, v5, vcc
    v_mfma_f32_16x16x32_bf16 v[28:31], v[24:27], a[72:75], v[28:31]
    s_mul_i32 s5, s5, 3
    s_add_u32 s4, s4, s5
    v_mfma_f32_16x16x32_bf16 v[28:31], v[24:27], a[76:79], v[28:31]
    s_add_u32 s4, s4, 479232
    v_writelane_b32 v90, s4, 4
    v_mfma_f32_16x16x32_bf16 v[28:31], v[24:27], a[80:83], v[28:31]
    v_mfma_f32_16x16x32_bf16 v[28:31], v[24:27], a[84:87], v[28:31]
    v_mfma_f32_16x16x32_bf16 v[28:31], v[24:27], a[88:91], v[28:31]
    v_mfma_f32_16x16x32_bf16 v[28:31], v[24:27], a[92:95], v[28:31]
    v_mfma_f32_16x16x32_bf16 v[28:31], v[24:27], a[96:99], v[28:31]
    v_mfma_f32_16x16x32_bf16 v[28:31], v[24:27], a[100:103], v[28:31]
    v_mfma_f32_16x16x32_bf16 v[28:31], v[24:27], a[104:107], v[28:31]
    v_mfma_f32_16x16x32_bf16 v[28:31], v[24:27], a[108:111], v[28:31]
    s_waitcnt vmcnt(0)
    s_cmp_eq_u32 s69, 0
    s_cbranch_scc1 Lfs1
    buffer_store_dword v15, v11, s[56:59], 0 offen
Lfd1:
    s_nop 3
    v_cvt_pk_bf16_f32 v92, v28, v28
    v_and_b32 v5, 0xffff0000, v92
    v_sub_f32 v5, v28, v5
    v_lshlrev_b32 v6, 16, v116
    v_cvt_pk_bf16_f32 v93, v5, v6
    v_cndmask_b32 v6, v92, 0, s[76:77]
    v_cndmask_b32 v7, v93, 0, s[76:77]
    v_cndmask_b32 v8, v116, 0, s[76:77]
    v_mov_b32 v9, 0
    v_cndmask_b32 v92, 0, v92, s[76:77]
    v_cndmask_b32 v93, 0, v93, s[76:77]
    v_cndmask_b32 v94, 0, v116, s[76:77]
    v_mov_b32 v95, 0
    v_mov_b32 v11, v90
    s_lshl_b32 m0, s60, 12
    s_mul_i32 s6, s60, 3072
    s_add_u32 s3, m0, 131072
    s_add_u32 s5, s6, 147456
    s_load_dwordx16 s[8:23], s[56:57], s74
    s_branch Lph
Lpfh:
    s_add_u32 s74, s74, 64
    s_and_b32 s81, s74, 448
    s_cbranch_scc0 Lpvh
    s_load_dwordx16 s[8:23], s[56:57], s74
Lph:
    s_waitcnt lgkmcnt(0)
    s_xor_b64 s[8:9], s[8:9], s[26:27]
    s_xor_b64 s[10:11], s[10:11], s[26:27]
    s_or_b64 s[8:9], s[8:9], s[10:11]
    s_xor_b64 s[12:13], s[12:13], s[26:27]
    s_or_b64 s[8:9], s[8:9], s[12:13]
    s_xor_b64 s[14:15], s[14:15], s[26:27]
    s_or_b64 s[8:9], s[8:9], s[14:15]
    s_xor_b64 s[16:17], s[16:17], s[26:27]
    s_branch Lsk5
Lstub5:
    s_setpc_b64 s[28:29]
Lsk5:
    s_or_b64 s[8:9], s[8:9], s[16:17]
    s_xor_b64 s[18:19], s[18:19], s[26:27]
    s_or_b64 s[8:9], s[8:9], s[18:19]
    s_xor_b64 s[20:21], s[20:21], s[26:27]
    s_or_b64 s[8:9], s[8:9], s[20:21]
    s_cbranch_scc1 Lpfh
Lpkh:
    buffer_load_dwordx4 v14, s[56:59], s3 offen offset:0 sc1 lds
    buffer_load_dwordx4 v14, s[56:59], s3 offen offset:1024 sc1 lds
    buffer_load_dwordx4 v14, s[56:59], s3 offen offset:2048 sc1 lds
    buffer_load_dwordx4 v14, s[56:59], s3 offen offset:3072 sc1 lds
    s_sub_u32 m0, s5, 131072
    s_nop 0
    buffer_load_dwordx4 v14, s[56:59], s5 offen offset:0 sc1 lds
    buffer_load_dwordx4 v14, s[56:59], s5 offen offset:1024 sc1 lds
    buffer_load_dwordx4 v14, s[56:59], s5 offen offset:2048 sc1 lds
    s_barrier
    s_add_u32 m0, s79, 28672
    s_add_u32 s3, m0, 131072
    buffer_load_dwordx4 v14, s[56:59], s3 offen offset:0 sc1 lds
    buffer_load_dwordx4 v14, s[56:59], s3 offen offset:1024 sc1 lds
    buffer_load_dwordx4 v14, s[56:59], s3 offen offset:2048 sc1 lds
    buffer_load_dwordx4 v14, s[56:59], s3 offen offset:3072 sc1 lds
    s_add_u32 m0, s79, 32768
    s_add_u32 s3, m0, 131072
    buffer_load_dwordx4 v14, s[56:59], s3 offen offset:0 sc1 lds
    buffer_load_dwordx4 v14, s[56:59], s3 offen offset:1024 sc1 lds
    buffer_load_dwordx4 v14, s[56:59], s3 offen offset:2048 sc1 lds
    s_mov_b32 s85, 57344
    s_mov_b32 s86, 114688
    s_mov_b32 s87, 172032
    s_cmp_lg_u32 s69, 0
    s_cselect_b64 vcc, -1, 0
    s_waitcnt vmcnt(10)
    s_barrier
    s_setprio 2
    ds_read_b128 v[48:51], v14 offset:0
    ds_read_b128 v[52:55], v14 offset:1024
    ds_read_b128 v[56:59], v14 offset:2048
    ds_read_b128 v[60:63], v14 offset:3072
    ds_read_b128 a[112:115], v14 offset:4096
    ds_read_b128 a[116:119], v14 offset:5120
    ds_read_b128 a[120:123], v14 offset:6144
    s_waitcnt lgkmcnt(4)
    v_mfma_f32_32x32x16_bf16 v[16:31], a[0:3], v[48:51], 0
    ds_read_b128 a[124:127], v14 offset:7168
    v_mfma_f32_32x32x16_bf16 v[16:31], a[4:7], v[52:55], v[16:31]
    ds_read_b128 v[48:51], v14 offset:8192
    v_mfma_f32_32x32x16_bf16 v[16:31], a[8:11], v[56:59], v[16:31]
    ds_read_b128 v[52:55], v14 offset:9216
    s_waitcnt lgkmcnt(4)
    v_mfma_f32_32x32x16_bf16 v[16:31], a[12:15], v[60:63], v[16:31]
    ds_read_b128 v[56:59], v14 offset:10240
    v_mfma_f32_32x32x16_bf16 v[16:31], a[16:19], a[112:115], v[16:31]
    ds_read_b128 v[60:63], v14 offset:11264
    v_mfma_f32_32x32x16_bf16 v[16:31], a[20:23], a[116:119], v[16:31]
    ds_read_b128 a[112:115], v14 offset:12288
    s_waitcnt lgkmcnt(4)
    v_mfma_f32_32x32x16_bf16 v[16:31], a[24:27], a[120:123], v[16:31]
    ds_read_b128 a[116:119], v14 offset:13312
    v_mfma_f32_32x32x16_bf16 v[16:31], a[28:31], a[124:127], v[16:31]
    ds_read_b128 a[120:123], v14 offset:14336
    v_mfma_f32_32x32x16_bf16 v[16:31], a[32:35], v[48:51], v[16:31]
    ds_read_b128 a[124:127], v14 offset:15360
    s_waitcnt lgkmcnt(4)
    v_mfma_f32_32x32x16_bf16 v[16:31], a[36:39], v[52:55], v[16:31]
    s_waitcnt vmcnt(7)
    s_barrier
    ds_read_b128 v[48:51], v14 offset:16384
    ds_read_b64 v[104:105], v117 offset:0
    ds_read_b64 v[32:33], v89 offset:0
    ds_read_b64 v[34:35], v89 offset:256
    ds_read_b64 v[36:37], v89 offset:512
    ds_read_b64 v[38:39], v89 offset:768
    v_mfma_f32_32x32x16_bf16 v[16:31], a[40:43], v[56:59], v[16:31]
    ds_read_b128 v[52:55], v14 offset:17408
    ds_read_b64 v[40:41], v89 offset:1024
    ds_read_b64 v[42:43], v89 offset:1280
    ds_read_b64 v[44:45], v89 offset:1536
    v_mov_b32 v123, 0
    v_mfma_f32_32x32x16_bf16 v[16:31], a[44:47], v[60:63], v[16:31]
    ds_read_b128 v[56:59], v14 offset:18432
    s_waitcnt lgkmcnt(12)
    v_mfma_f32_32x32x16_bf16 v[16:31], a[48:51], a[112:115], v[16:31]
    ds_read_b128 v[60:63], v14 offset:19456
    s_waitcnt lgkmcnt(2)
    v_add_f32 v32, v32, v34
    v_add_f32 v33, v33, v35
    v_add_f32 v36, v36, v38
    v_mfma_f32_32x32x16_bf16 v[16:31], a[52:55], a[116:119], v[16:31]
    ds_read_b128 a[112:115], v14 offset:20480
    v_add_f32 v37, v37, v39
    v_add_f32 v40, v40, v42
    v_add_f32 v41, v41, v43
    v_add_f32 v32, v32, v36
    v_add_f32 v33, v33, v37
    v_mfma_f32_32x32x16_bf16 v[16:31], a[56:59], a[120:123], v[16:31]
    ds_read_b128 a[116:119], v14 offset:21504
    v_add_f32 v40, v40, v44
    v_add_f32 v41, v41, v45
    v_add_f32 v32, v32, v40
    v_add_f32 v33, v33, v41
    v_mul_f32 v32, 3138537765, v32
    v_mfma_f32_32x32x16_bf16 v[16:31], a[60:63], a[124:127], v[16:31]
    ds_read_b128 a[120:123], v14 offset:22528
    v_mul_f32 v33, 991054117, v33
    v_fma_f32 v33, -v32, v32, v33
    v_max_f32 v33, 0, v33
    v_add_f32 v33, 925353388, v33
    v_rsq_f32 v34, v33
    v_mfma_f32_32x32x16_bf16 v[16:31], a[64:67], v[48:51], v[16:31]
    ds_read_b128 a[124:127], v14 offset:23552
    v_mul_f32 v98, v33, v34
    v_mul_f32 v96, 3222493025, v34
    v_mul_f32 v35, v34, v34
    v_mul_f32 v35, 1027024659, v35
    v_mfma_f32_32x32x16_bf16 v[16:31], a[68:71], v[52:55], v[16:31]
    ds_read_b128 v[48:51], v14 offset:24576
    v_mul_f32 v97, v35, v96
    v_cvt_pk_bf16_f32 v121, v32, v98
    v_lshlrev_b32 v36, 16, v121
    v_and_b32 v37, 0xffff0000, v121
    v_sub_f32 v38, v32, v36
    s_waitcnt lgkmcnt(4)
    v_mfma_f32_32x32x16_bf16 v[16:31], a[72:75], v[56:59], v[16:31]
    ds_read_b128 v[52:55], v14 offset:25600
    v_sub_f32 v39, v98, v37
    v_cvt_pk_bf16_f32 v120, v36, v38
    v_cvt_pk_bf16_f32 v122, v39, 0
    v_mov_b32 v100, v96
    v_mov_b32 v101, v97
    v_mov_b32 v102, v98
    v_mfma_f32_32x32x16_bf16 v[16:31], a[76:79], v[60:63], v[16:31]
    ds_read_b128 v[56:59], v14 offset:26624
    v_permlane32_swap_b32 v96, v100
    v_permlane32_swap_b32 v97, v101
    v_permlane32_swap_b32 v98, v102
    ds_read_b64 v[32:33], v89 offset:4096
    ds_read_b64 v[34:35], v89 offset:4352
    v_mfma_f32_32x32x16_bf16 v[16:31], a[80:83], a[112:115], v[16:31]
    ds_read_b128 v[60:63], v14 offset:27648
    ds_read_b64 v[36:37], v89 offset:4608
    ds_read_b64 v[38:39], v89 offset:4864
    ds_read_b64 v[40:41], v89 offset:5120
    ds_read_b64 v[42:43], v89 offset:5376
    ds_read_b64 v[44:45], v89 offset:5632
    s_waitcnt lgkmcnt(11)
    v_mfma_f32_32x32x16_bf16 v[16:31], a[84:87], a[116:119], v[16:31]
    s_waitcnt vmcnt(0)
    s_barrier
    ds_read_b128 a[112:115], v14 offset:28672
    v_mov_b32 v5, 0
    v_mfma_f32_32x32x16_bf16 v[16:31], a[88:91], a[120:123], v[16:31]
    ds_read_b128 a[116:119], v14 offset:29696
    s_waitcnt lgkmcnt(2)
    v_mfma_f32_32x32x16_bf16 v[16:31], a[92:95], a[124:127], v[16:31]
    ds_read_b128 a[120:123], v14 offset:30720
    v_add_f32 v32, v32, v34
    v_add_f32 v33, v33, v35
    v_add_f32 v36, v36, v38
    v_add_f32 v37, v37, v39
    v_add_f32 v40, v40, v42
    v_mfma_f32_32x32x16_bf16 v[16:31], a[96:99], v[48:51], v[16:31]
    ds_read_b128 a[124:127], v14 offset:31744
    v_add_f32 v41, v41, v43
    v_add_f32 v32, v32, v36
    v_add_f32 v33, v33, v37
    v_add_f32 v40, v40, v44
    v_add_f32 v41, v41, v45
    v_mfma_f32_32x32x16_bf16 v[16:31], a[100:103], v[52:55], v[16:31]
    ds_read_b128 v[48:51], v14 offset:32768
    v_add_f32 v32, v32, v40
    v_add_f32 v33, v33, v41
    v_mul_f32 v32, 3138537765, v32
    v_mul_f32 v33, 991054117, v33
    v_fma_f32 v33, -v32, v32, v33
    v_max_f32 v33, 0, v33
    v_mfma_f32_32x32x16_bf16 v[16:31], a[104:107], v[56:59], v[16:31]
    ds_read_b128 v[52:55], v14 offset:33792
    v_add_f32 v33, 925353388, v33
    v_rsq_f32 v34, v33
    s_nop 0
    v_mul_f32 v116, v33, v34
    v_mul_f32 v90, 3222493025, v34
    v_mfma_f32_32x32x16_bf16 v[16:31], a[108:111], v[60:63], v[16:31]
    ds_read_b128 v[56:59], v14 offset:34816
    v_mul_f32 v35, v34, v34
    v_mul_f32 v35, 1027024659, v35
    v_mul_f32 v91, v35, v90
    v_cvt_pk_bf16_f32 v3, v32, v116
    v_lshlrev_b32 v36, 16, v3
    v_mfma_f32_32x32x16_bf16 v[16:31], v[92:95], v[120:123], v[16:31]
    v_and_b32 v37, 0xffff0000, v3
    v_sub_f32 v38, v32, v36
    v_sub_f32 v39, v116, v37
    v_cvt_pk_bf16_f32 v2, v36, v38
    v_cvt_pk_bf16_f32 v4, v39, 0
    s_waitcnt lgkmcnt(4)
    v_mfma_f32_32x32x16_bf16 v[32:47], a[0:3], a[112:115], 0
    ds_read_b128 v[60:63], v14 offset:35840
    ds_read_b64 v[106:107], v117 offset:28672
    v_mfma_f32_32x32x16_bf16 v[32:47], a[4:7], a[116:119], v[32:47]
    ds_read_b128 a[112:115], v14 offset:36864
    s_nop 0
    v_mul_f32 v64, v16, v16
    v_mfma_f32_32x32x16_bf16 v[32:47], a[8:11], a[120:123], v[32:47]
    ds_read_b128 a[116:119], v14 offset:37888
    v_mul_f32 v65, v17, v17
    v_mul_f32 v66, v18, v18
    v_mul_f32 v67, v19, v19
    v_mul_f32 v68, v20, v20
    v_mul_f32 v69, v21, v21
    v_mul_f32 v70, v22, v22
    s_waitcnt lgkmcnt(5)
    v_mfma_f32_32x32x16_bf16 v[32:47], a[12:15], a[124:127], v[32:47]
    ds_read_b128 a[120:123], v14 offset:38912
    v_mul_f32 v71, v23, v23
    v_fma_f32 v64, v64, v97, v96
    v_fma_f32 v65, v65, v97, v96
    v_fma_f32 v66, v66, v97, v96
    v_fma_f32 v67, v67, v97, v96
    v_fma_f32 v68, v68, v97, v96
    v_mfma_f32_32x32x16_bf16 v[32:47], a[16:19], v[48:51], v[32:47]
    ds_read_b128 a[124:127], v14 offset:39936
    v_fma_f32 v69, v69, v97, v96
    v_fma_f32 v70, v70, v97, v96
    v_fma_f32 v71, v71, v97, v96
    v_mul_f32 v64, v64, v16
    v_mul_f32 v65, v65, v17
    v_mfma_f32_32x32x16_bf16 v[32:47], a[20:23], v[52:55], v[32:47]
    ds_read_b128 v[48:51], v14 offset:40960
    v_mul_f32 v66, v66, v18
    v_mul_f32 v67, v67, v19
    v_mul_f32 v68, v68, v20
    v_mul_f32 v69, v69, v21
    v_mul_f32 v70, v70, v22
    v_mul_f32 v71, v71, v23
    s_waitcnt lgkmcnt(4)
    v_mfma_f32_32x32x16_bf16 v[32:47], a[24:27], v[56:59], v[32:47]
    ds_read_b128 v[52:55], v14 offset:41984
    v_exp_f32 v64, v64
    v_exp_f32 v65, v65
    v_exp_f32 v66, v66
    v_mfma_f32_32x32x16_bf16 v[32:47], a[28:31], v[60:63], v[32:47]
    ds_read_b128 v[56:59], v14 offset:43008
    v_exp_f32 v67, v67
    v_exp_f32 v68, v68
    v_exp_f32 v69, v69
    v_mfma_f32_32x32x16_bf16 v[32:47], a[32:35], a[112:115], v[32:47]
    ds_read_b128 v[60:63], v14 offset:44032
    v_exp_f32 v70, v70
    v_exp_f32 v71, v71
    v_fma_f32 v64, v64, v98, v98
    v_fma_f32 v65, v65, v98, v98
    s_waitcnt lgkmcnt(4)
    v_mfma_f32_32x32x16_bf16 v[32:47], a[36:39], a[116:119], v[32:47]
    ds_read_b128 a[112:115], v14 offset:45056
    v_fma_f32 v66, v66, v98, v98
    v_fma_f32 v67, v67, v98, v98
    v_fma_f32 v68, v68, v98, v98
    v_fma_f32 v69, v69, v98, v98
    v_fma_f32 v70, v70, v98, v98
    v_fma_f32 v71, v71, v98, v98
    v_mfma_f32_32x32x16_bf16 v[32:47], a[40:43], a[120:123], v[32:47]
    ds_read_b128 a[116:119], v14 offset:46080
    v_rcp_f32 v64, v64
    v_rcp_f32 v65, v65
    v_rcp_f32 v66, v66
    v_mfma_f32_32x32x16_bf16 v[32:47], a[44:47], a[124:127], v[32:47]
    ds_read_b128 a[120:123], v14 offset:47104
    v_rcp_f32 v67, v67
    v_rcp_f32 v68, v68
    v_rcp_f32 v69, v69
    s_waitcnt lgkmcnt(4)
    v_mfma_f32_32x32x16_bf16 v[32:47], a[48:51], v[48:51], v[32:47]
    ds_read_b128 a[124:127], v14 offset:48128
    v_rcp_f32 v70, v70
    v_rcp_f32 v71, v71
    v_mul_f32 v64, v64, v16
    v_mul_f32 v65, v65, v17
    v_mfma_f32_32x32x16_bf16 v[32:47], a[52:55], v[52:55], v[32:47]
    ds_read_b128 v[48:51], v14 offset:49152
    v_mul_f32 v66, v66, v18
    v_mul_f32 v67, v67, v19
    v_mul_f32 v68, v68, v20
    v_mul_f32 v69, v69, v21
    v_mul_f32 v70, v70, v22
    v_mul_f32 v71, v71, v23
    v_mfma_f32_32x32x16_bf16 v[32:47], a[56:59], v[56:59], v[32:47]
    ds_read_b128 v[52:55], v14 offset:50176
    v_cvt_pk_bf16_f32 v72, v64, v65
    v_cvt_pk_bf16_f32 v73, v66, v67
    v_cvt_pk_bf16_f32 v74, v68, v69
    v_cvt_pk_bf16_f32 v75, v70, v71
    s_waitcnt lgkmcnt(4)
    v_mfma_f32_32x32x16_bf16 v[32:47], a[60:63], v[60:63], v[32:47]
    ds_read_b128 v[56:59], v14 offset:51200
    buffer_store_dwordx4 v[72:75], v12, s[56:59], 0 offen offset:0 sc1
    v_mul_f32 v64, v24, v24
    v_mul_f32 v65, v25, v25
    v_mul_f32 v66, v26, v26
    v_mul_f32 v67, v27, v27
    v_mfma_f32_32x32x16_bf16 v[32:47], a[64:67], a[112:115], v[32:47]
    ds_read_b128 v[60:63], v14 offset:52224
    v_mul_f32 v68, v28, v28
    v_mul_f32 v69, v29, v29
    v_mul_f32 v70, v30, v30
    v_mul_f32 v71, v31, v31
    v_fma_f32 v64, v64, v97, v96
    v_mfma_f32_32x32x16_bf16 v[32:47], a[68:71], a[116:119], v[32:47]
    ds_read_b128 a[112:115], v14 offset:53248
    v_fma_f32 v65, v65, v97, v96
    v_fma_f32 v66, v66, v97, v96
    v_fma_f32 v67, v67, v97, v96
    v_fma_f32 v68, v68, v97, v96
    v_fma_f32 v69, v69, v97, v96
    v_fma_f32 v70, v70, v97, v96
    s_waitcnt lgkmcnt(4)
    v_mfma_f32_32x32x16_bf16 v[32:47], a[72:75], a[120:123], v[32:47]
    ds_read_b128 a[116:119], v14 offset:54272
    v_fma_f32 v71, v71, v97, v96
    v_mul_f32 v64, v64, v24
    v_mul_f32 v65, v65, v25
    v_mul_f32 v66, v66, v26
    v_mul_f32 v67, v67, v27
    v_mul_f32 v68, v68, v28
    v_mfma_f32_32x32x16_bf16 v[32:47], a[76:79], a[124:127], v[32:47]
    ds_read_b128 a[120:123], v14 offset:55296
    v_mul_f32 v69, v69, v29
    v_mul_f32 v70, v70, v30
    v_mul_f32 v71, v71, v31
    v_exp_f32 v64, v64
    v_mfma_f32_32x32x16_bf16 v[32:47], a[80:83], v[48:51], v[32:47]
    ds_read_b128 a[124:127], v14 offset:56320
    v_exp_f32 v65, v65
    v_exp_f32 v66, v66
    v_exp_f32 v67, v67
    s_waitcnt lgkmcnt(4)
    v_mfma_f32_32x32x16_bf16 v[32:47], a[84:87], v[52:55], v[32:47]
    s_barrier
    ds_read_b128 v[48:51], v88 offset:0
    v_exp_f32 v68, v68
    v_exp_f32 v69, v69
    v_exp_f32 v70, v70
    v_exp_f32 v71, v71
    v_mfma_f32_32x32x16_bf16 v[32:47], a[88:91], v[56:59], v[32:47]
    ds_read_b128 v[52:55], v88 offset:1024
    v_fma_f32 v64, v64, v98, v98
    v_fma_f32 v65, v65, v98, v98
    v_fma_f32 v66, v66, v98, v98
    v_fma_f32 v67, v67, v98, v98
    v_fma_f32 v68, v68, v98, v98
    v_mfma_f32_32x32x16_bf16 v[32:47], a[92:95], v[60:63], v[32:47]
    ds_read_b128 v[56:59], v88 offset:2048
    v_fma_f32 v69, v69, v98, v98
    v_fma_f32 v70, v70, v98, v98
    v_fma_f32 v71, v71, v98, v98
    v_rcp_f32 v64, v64
    s_waitcnt lgkmcnt(4)
    v_mfma_f32_32x32x16_bf16 v[32:47], a[96:99], a[112:115], v[32:47]
    ds_read_b128 v[60:63], v88 offset:3072
    v_rcp_f32 v65, v65
    v_rcp_f32 v66, v66
    v_rcp_f32 v67, v67
    v_mfma_f32_32x32x16_bf16 v[32:47], a[100:103], a[116:119], v[32:47]
    ds_read_b128 a[112:115], v88 offset:4096
    v_rcp_f32 v68, v68
    v_rcp_f32 v69, v69
    v_rcp_f32 v70, v70
    v_mfma_f32_32x32x16_bf16 v[32:47], a[104:107], a[120:123], v[32:47]
    ds_read_b128 a[116:119], v88 offset:5120
    v_rcp_f32 v71, v71
    v_mul_f32 v64, v64, v24
    v_mul_f32 v65, v65, v25
    v_mul_f32 v66, v66, v26
    v_mul_f32 v67, v67, v27
    s_waitcnt lgkmcnt(4)
    v_mfma_f32_32x32x16_bf16 v[32:47], a[108:111], a[124:127], v[32:47]
    ds_read_b128 a[120:123], v88 offset:6144
    v_mul_f32 v68, v68, v28
    v_mul_f32 v69, v69, v29
    v_mul_f32 v70, v70, v30
    v_mul_f32 v71, v71, v31
    v_cvt_pk_bf16_f32 v76, v64, v65
    v_cvt_pk_bf16_f32 v77, v66, v67
    v_mfma_f32_32x32x16_bf16 v[32:47], v[6:9], v[120:123], v[32:47]
    v_cvt_pk_bf16_f32 v78, v68, v69
    v_cvt_pk_bf16_f32 v79, v70, v71
    buffer_store_dwordx4 v[76:79], v12, s[56:59], 0 offen offset:512 sc1
    v_mfma_f32_32x32x16_bf16 v[16:31], a[0:3], v[48:51], 0
    ds_read_b128 a[124:127], v88 offset:7168
    ds_read_b64 v[108:109], v118 offset:0
    v_mov_b32 v96, v90
    v_mov_b32 v97, v91
    v_mov_b32 v98, v116
    v_permlane32_swap_b32 v96, v90
    v_permlane32_swap_b32 v97, v91
    v_mfma_f32_32x32x16_bf16 v[16:31], a[4:7], v[52:55], v[16:31]
    ds_read_b128 v[48:51], v88 offset:8192
    v_permlane32_swap_b32 v98, v116
    v_mul_f32 v64, v32, v32
    v_mul_f32 v65, v33, v33
    v_mul_f32 v66, v34, v34
    v_mul_f32 v67, v35, v35
    v_mul_f32 v68, v36, v36
    s_waitcnt lgkmcnt(5)
    v_mfma_f32_32x32x16_bf16 v[16:31], a[8:11], v[56:59], v[16:31]
    ds_read_b128 v[52:55], v88 offset:9216
    v_mul_f32 v69, v37, v37
    v_mul_f32 v70, v38, v38
    v_mul_f32 v71, v39, v39
    v_fma_f32 v64, v64, v101, v100
    v_fma_f32 v65, v65, v101, v100
    v_mfma_f32_32x32x16_bf16 v[16:31], a[12:15], v[60:63], v[16:31]
    ds_read_b128 v[56:59], v88 offset:10240
    v_fma_f32 v66, v66, v101, v100
    v_fma_f32 v67, v67, v101, v100
    v_fma_f32 v68, v68, v101, v100
    v_fma_f32 v69, v69, v101, v100
    v_fma_f32 v70, v70, v101, v100
    v_fma_f32 v71, v71, v101, v100
    v_mfma_f32_32x32x16_bf16 v[16:31], a[16:19], a[112:115], v[16:31]
    ds_read_b128 v[60:63], v88 offset:11264
    v_mul_f32 v64, v64, v32
    v_mul_f32 v65, v65, v33
    v_mul_f32 v66, v66, v34
    v_mul_f32 v67, v67, v35
    v_mul_f32 v68, v68, v36
    v_mul_f32 v69, v69, v37
    s_waitcnt lgkmcnt(5)
    v_mfma_f32_32x32x16_bf16 v[16:31], a[20:23], a[116:119], v[16:31]
    ds_read_b128 a[112:115], v88 offset:12288
    v_mul_f32 v70, v70, v38
    v_mul_f32 v71, v71, v39
    v_exp_f32 v64, v64
    v_exp_f32 v65, v65
    v_mfma_f32_32x32x16_bf16 v[16:31], a[24:27], a[120:123], v[16:31]
    ds_read_b128 a[116:119], v88 offset:13312
    v_exp_f32 v66, v66
    v_exp_f32 v67, v67
    v_exp_f32 v68, v68
    v_mfma_f32_32x32x16_bf16 v[16:31], a[28:31], a[124:127], v[16:31]
    ds_read_b128 a[120:123], v88 offset:14336
    v_exp_f32 v69, v69
    v_exp_f32 v70, v70
    v_exp_f32 v71, v71
    s_waitcnt lgkmcnt(4)
    v_mfma_f32_32x32x16_bf16 v[16:31], a[32:35], v[48:51], v[16:31]
    ds_read_b128 a[124:127], v88 offset:15360
    v_fma_f32 v64, v64, v102, v102
    v_fma_f32 v65, v65, v102, v102
    v_fma_f32 v66, v66, v102, v102
    v_fma_f32 v67, v67, v102, v102
    v_fma_f32 v68, v68, v102, v102
    v_mfma_f32_32x32x16_bf16 v[16:31], a[36:39], v[52:55], v[16:31]
    ds_read_b128 v[48:51], v88 offset:16384
    v_fma_f32 v69, v69, v102, v102
    v_fma_f32 v70, v70, v102, v102
    v_fma_f32 v71, v71, v102, v102
    v_rcp_f32 v64, v64
    v_mfma_f32_32x32x16_bf16 v[16:31], a[40:43], v[56:59], v[16:31]
    ds_read_b128 v[52:55], v88 offset:17408
    v_rcp_f32 v65, v65
    v_rcp_f32 v66, v66
    v_rcp_f32 v67, v67
    s_waitcnt lgkmcnt(4)
    v_mfma_f32_32x32x16_bf16 v[16:31], a[44:47], v[60:63], v[16:31]
    ds_read_b128 v[56:59], v88 offset:18432
    v_rcp_f32 v68, v68
    v_rcp_f32 v69, v69
    v_rcp_f32 v70, v70
    v_mfma_f32_32x32x16_bf16 v[16:31], a[48:51], a[112:115], v[16:31]
    ds_read_b128 v[60:63], v88 offset:19456
    v_rcp_f32 v71, v71
    v_mul_f32 v64, v64, v32
    v_mul_f32 v65, v65, v33
    v_mul_f32 v66, v66, v34
    v_mul_f32 v67, v67, v35
    v_mfma_f32_32x32x16_bf16 v[16:31], a[52:55], a[116:119], v[16:31]
    ds_read_b128 a[112:115], v88 offset:20480
    v_mul_f32 v68, v68, v36
    v_mul_f32 v69, v69, v37
    v_mul_f32 v70, v70, v38
    v_mul_f32 v71, v71, v39
    v_cvt_pk_bf16_f32 v80, v64, v65
    v_cvt_pk_bf16_f32 v81, v66, v67
    s_waitcnt lgkmcnt(4)
    v_mfma_f32_32x32x16_bf16 v[16:31], a[56:59], a[120:123], v[16:31]
    ds_read_b128 a[116:119], v88 offset:21504
    v_cvt_pk_bf16_f32 v82, v68, v69
    v_cvt_pk_bf16_f32 v83, v70, v71
    buffer_store_dwordx4 v[80:83], v12, s[56:59], s85 offen offset:0 sc1
    v_mfma_f32_32x32x16_bf16 v[16:31], a[60:63], a[124:127], v[16:31]
    ds_read_b128 a[120:123], v88 offset:22528
    v_mul_f32 v64, v40, v40
    v_mul_f32 v65, v41, v41
    v_mul_f32 v66, v42, v42
    v_mul_f32 v67, v43, v43
    v_mul_f32 v68, v44, v44
    v_mfma_f32_32x32x16_bf16 v[16:31], a[64:67], v[48:51], v[16:31]
    ds_read_b128 a[124:127], v88 offset:23552
    v_mul_f32 v69, v45, v45
    v_mul_f32 v70, v46, v46
    v_mul_f32 v71, v47, v47
    v_fma_f32 v64, v64, v101, v100
    v_fma_f32 v65, v65, v101, v100
    v_fma_f32 v66, v66, v101, v100
    s_waitcnt lgkmcnt(4)
    v_mfma_f32_32x32x16_bf16 v[16:31], a[68:71], v[52:55], v[16:31]
    ds_read_b128 v[48:51], v88 offset:24576
    v_fma_f32 v67, v67, v101, v100
    v_fma_f32 v68, v68, v101, v100
    v_fma_f32 v69, v69, v101, v100
    v_fma_f32 v70, v70, v101, v100
    v_fma_f32 v71, v71, v101, v100
    v_mfma_f32_32x32x16_bf16 v[16:31], a[72:75], v[56:59], v[16:31]
    ds_read_b128 v[52:55], v88 offset:25600
    v_mul_f32 v64, v64, v40
    v_mul_f32 v65, v65, v41
    v_mul_f32 v66, v66, v42
    v_mul_f32 v67, v67, v43
    v_mul_f32 v68, v68, v44
    v_mul_f32 v69, v69, v45
    v_mfma_f32_32x32x16_bf16 v[16:31], a[76:79], v[60:63], v[16:31]
    ds_read_b128 v[56:59], v88 offset:26624
    v_mul_f32 v70, v70, v46
    v_mul_f32 v71, v71, v47
    v_exp_f32 v64, v64
    v_exp_f32 v65, v65
    s_waitcnt lgkmcnt(4)
    v_mfma_f32_32x32x16_bf16 v[16:31], a[80:83], a[112:115], v[16:31]
    ds_read_b128 v[60:63], v88 offset:27648
    v_exp_f32 v66, v66
    v_exp_f32 v67, v67
    v_exp_f32 v68, v68
    v_mfma_f32_32x32x16_bf16 v[16:31], a[84:87], a[116:119], v[16:31]
    ds_read_b128 a[112:115], v88 offset:28672
    v_exp_f32 v69, v69
    v_exp_f32 v70, v70
    v_exp_f32 v71, v71
    v_mfma_f32_32x32x16_bf16 v[16:31], a[88:91], a[120:123], v[16:31]
    ds_read_b128 a[116:119], v88 offset:29696
    v_fma_f32 v64, v64, v102, v102
    v_fma_f32 v65, v65, v102, v102
    v_fma_f32 v66, v66, v102, v102
    v_fma_f32 v67, v67, v102, v102
    v_fma_f32 v68, v68, v102, v102
    s_waitcnt vmcnt(1)
    s_cmp_eq_u32 s69, 0
    s_cbranch_scc1 Lfs2
    buffer_store_dword v15, v11, s[56:59], 0 offen
Lfd2:
    s_waitcnt lgkmcnt(4)
    v_mfma_f32_32x32x16_bf16 v[16:31], a[92:95], a[124:127], v[16:31]
    ds_read_b128 a[120:123], v88 offset:30720
    v_fma_f32 v69, v69, v102, v102
    v_fma_f32 v70, v70, v102, v102
    v_fma_f32 v71, v71, v102, v102
    v_rcp_f32 v64, v64
    v_mfma_f32_32x32x16_bf16 v[16:31], a[96:99], v[48:51], v[16:31]
    ds_read_b128 a[124:127], v88 offset:31744
    v_rcp_f32 v65, v65
    v_rcp_f32 v66, v66
    v_rcp_f32 v67, v67
    v_mfma_f32_32x32x16_bf16 v[16:31], a[100:103], v[52:55], v[16:31]
    ds_read_b128 v[48:51], v88 offset:32768
    v_rcp_f32 v68, v68
    v_rcp_f32 v69, v69
    v_rcp_f32 v70, v70
    s_waitcnt lgkmcnt(4)
    v_mfma_f32_32x32x16_bf16 v[16:31], a[104:107], v[56:59], v[16:31]
    ds_read_b128 v[52:55], v88 offset:33792
    v_rcp_f32 v71, v71
    v_mul_f32 v64, v64, v40
    v_mul_f32 v65, v65, v41
    v_mul_f32 v66, v66, v42
    v_mul_f32 v67, v67, v43
    v_mul_f32 v68, v68, v44
    v_mfma_f32_32x32x16_bf16 v[16:31], a[108:111], v[60:63], v[16:31]
    ds_read_b128 v[56:59], v88 offset:34816
    v_mul_f32 v69, v69, v45
    v_mul_f32 v70, v70, v46
    v_mul_f32 v71, v71, v47
    v_cvt_pk_bf16_f32 v84, v64, v65
    v_cvt_pk_bf16_f32 v85, v66, v67
    v_mfma_f32_32x32x16_bf16 v[16:31], v[92:95], v[2:5], v[16:31]
    v_cvt_pk_bf16_f32 v86, v68, v69
    v_cvt_pk_bf16_f32 v87, v70, v71
    buffer_store_dwordx4 v[84:87], v12, s[56:59], s85 offen offset:512 sc1
    v_mfma_f32_32x32x16_bf16 v[32:47], a[0:3], a[112:115], 0
    ds_read_b128 v[60:63], v88 offset:35840
    ds_read_b64 v[110:111], v118 offset:28672
    s_waitcnt lgkmcnt(5)
    v_mfma_f32_32x32x16_bf16 v[32:47], a[4:7], a[116:119], v[32:47]
    ds_read_b128 a[112:115], v88 offset:36864
    s_nop 2
    v_mul_f32 v64, v16, v16
    v_mul_f32 v65, v17, v17
    v_mul_f32 v66, v18, v18
    v_mul_f32 v67, v19, v19
    v_mul_f32 v68, v20, v20
    v_mul_f32 v69, v21, v21
    v_mul_f32 v70, v22, v22
    v_mfma_f32_32x32x16_bf16 v[32:47], a[8:11], a[120:123], v[32:47]
    ds_read_b128 a[116:119], v88 offset:37888
    v_mul_f32 v71, v23, v23
    v_fma_f32 v64, v64, v97, v96
    v_fma_f32 v65, v65, v97, v96
    v_fma_f32 v66, v66, v97, v96
    v_fma_f32 v67, v67, v97, v96
    v_fma_f32 v68, v68, v97, v96
    v_fma_f32 v69, v69, v97, v96
    v_fma_f32 v70, v70, v97, v96
    v_mfma_f32_32x32x16_bf16 v[32:47], a[12:15], a[124:127], v[32:47]
    ds_read_b128 a[120:123], v88 offset:38912
    v_fma_f32 v71, v71, v97, v96
    v_mul_f32 v64, v64, v16
    v_mul_f32 v65, v65, v17
    v_mul_f32 v66, v66, v18
    v_mul_f32 v67, v67, v19
    v_mul_f32 v68, v68, v20
    v_mul_f32 v69, v69, v21
    v_mul_f32 v70, v70, v22
    s_waitcnt lgkmcnt(5)
    v_mfma_f32_32x32x16_bf16 v[32:47], a[16:19], v[48:51], v[32:47]
    ds_read_b128 a[124:127], v88 offset:39936
    v_mul_f32 v71, v71, v23
    v_exp_f32 v64, v64
    v_exp_f32 v65, v65
    v_exp_f32 v66, v66
    v_exp_f32 v67, v67
    v_mfma_f32_32x32x16_bf16 v[32:47], a[20:23], v[52:55], v[32:47]
    ds_read_b128 v[48:51], v88 offset:40960
    v_exp_f32 v68, v68
    v_exp_f32 v69, v69
    v_exp_f32 v70, v70
    v_exp_f32 v71, v71
    v_fma_f32 v64, v64, v98, v98
    v_mfma_f32_32x32x16_bf16 v[32:47], a[24:27], v[56:59], v[32:47]
    ds_read_b128 v[52:55], v88 offset:41984
    v_fma_f32 v65, v65, v98, v98
    v_fma_f32 v66, v66, v98, v98
    v_fma_f32 v67, v67, v98, v98
    v_fma_f32 v68, v68, v98, v98
    v_fma_f32 v69, v69, v98, v98
    v_fma_f32 v70, v70, v98, v98
    v_fma_f32 v71, v71, v98, v98
    s_waitcnt lgkmcnt(4)
    v_mfma_f32_32x32x16_bf16 v[32:47], a[28:31], v[60:63], v[32:47]
    ds_read_b128 v[56:59], v88 offset:43008
    v_rcp_f32 v64, v64
    v_rcp_f32 v65, v65
    v_rcp_f32 v66, v66
    v_rcp_f32 v67, v67
    v_rcp_f32 v68, v68
    v_mfma_f32_32x32x16_bf16 v[32:47], a[32:35], a[112:115], v[32:47]
    ds_read_b128 v[60:63], v88 offset:44032
    v_rcp_f32 v69, v69
    v_rcp_f32 v70, v70
    v_rcp_f32 v71, v71
    v_mul_f32 v64, v64, v16
    v_mul_f32 v65, v65, v17
    v_mfma_f32_32x32x16_bf16 v[32:47], a[36:39], a[116:119], v[32:47]
    ds_read_b128 a[112:115], v88 offset:45056
    v_mul_f32 v66, v66, v18
    s_branch Lsk6
Lstub6:
    s_setpc_b64 s[28:29]
Lsk6:
    v_mul_f32 v67, v67, v19
    v_mul_f32 v68, v68, v20
    v_mul_f32 v69, v69, v21
    v_mul_f32 v70, v70, v22
    v_mul_f32 v71, v71, v23
    v_cvt_pk_bf16_f32 v72, v64, v65
    v_cvt_pk_bf16_f32 v73, v66, v67
    v_cvt_pk_bf16_f32 v74, v68, v69
    s_waitcnt lgkmcnt(4)
    v_mfma_f32_32x32x16_bf16 v[32:47], a[40:43], a[120:123], v[32:47]
    ds_read_b128 a[116:119], v88 offset:46080
    v_cvt_pk_bf16_f32 v75, v70, v71
    buffer_store_dwordx4 v[72:75], v12, s[56:59], s86 offen offset:0 sc1
    v_mul_f32 v64, v24, v24
    v_mul_f32 v65, v25, v25
    v_mul_f32 v66, v26, v26
    v_mfma_f32_32x32x16_bf16 v[32:47], a[44:47], a[124:127], v[32:47]
    ds_read_b128 a[120:123], v88 offset:47104
    v_mul_f32 v67, v27, v27
    v_mul_f32 v68, v28, v28
    v_mul_f32 v69, v29, v29
    v_mul_f32 v70, v30, v30
    v_mul_f32 v71, v31, v31
    v_fma_f32 v64, v64, v97, v96
    v_fma_f32 v65, v65, v97, v96
    v_fma_f32 v66, v66, v97, v96
    v_fma_f32 v67, v67, v97, v96
    v_mfma_f32_32x32x16_bf16 v[32:47], a[48:51], v[48:51], v[32:47]
    ds_read_b128 a[124:127], v88 offset:48128
    v_fma_f32 v68, v68, v97, v96
    v_fma_f32 v69, v69, v97, v96
    v_fma_f32 v70, v70, v97, v96
    v_fma_f32 v71, v71, v97, v96
    v_mul_f32 v64, v64, v24
    v_mul_f32 v65, v65, v25
    v_mul_f32 v66, v66, v26
    v_mul_f32 v67, v67, v27
    s_waitcnt lgkmcnt(4)
    v_mfma_f32_32x32x16_bf16 v[32:47], a[52:55], v[52:55], v[32:47]
    ds_read_b128 v[48:51], v88 offset:49152
    v_mul_f32 v68, v68, v28
    v_mul_f32 v69, v69, v29
    v_mul_f32 v70, v70, v30
    v_mul_f32 v71, v71, v31
    v_exp_f32 v64, v64
    v_exp_f32 v65, v65
    v_mfma_f32_32x32x16_bf16 v[32:47], a[56:59], v[56:59], v[32:47]
    ds_read_b128 v[52:55], v88 offset:50176
    v_exp_f32 v66, v66
    v_exp_f32 v67, v67
    v_exp_f32 v68, v68
    v_exp_f32 v69, v69
    v_exp_f32 v70, v70
    v_mfma_f32_32x32x16_bf16 v[32:47], a[60:63], v[60:63], v[32:47]
    ds_read_b128 v[56:59], v88 offset:51200
    v_exp_f32 v71, v71
    v_fma_f32 v64, v64, v98, v98
    v_fma_f32 v65, v65, v98, v98
    v_fma_f32 v66, v66, v98, v98
    v_fma_f32 v67, v67, v98, v98
    v_fma_f32 v68, v68, v98, v98
    v_fma_f32 v69, v69, v98, v98
    s_waitcnt lgkmcnt(4)
    v_mfma_f32_32x32x16_bf16 v[32:47], a[64:67], a[112:115], v[32:47]
    ds_read_b128 v[60:63], v88 offset:52224
    v_fma_f32 v70, v70, v98, v98
    v_fma_f32 v71, v71, v98, v98
    v_rcp_f32 v64, v64
    v_rcp_f32 v65, v65
    v_rcp_f32 v66, v66
    v_mfma_f32_32x32x16_bf16 v[32:47], a[68:71], a[116:119], v[32:47]
    ds_read_b128 a[112:115], v88 offset:53248
    v_rcp_f32 v67, v67
    v_rcp_f32 v68, v68
    v_rcp_f32 v69, v69
    v_rcp_f32 v70, v70
    s_waitcnt vmcnt(1)
    s_cmp_eq_u32 s69, 0
    s_cbranch_scc1 Lfs3
    buffer_store_dword v15, v11, s[56:59], 0 offen offset:1024
Lfd3:
    v_mfma_f32_32x32x16_bf16 v[32:47], a[72:75], a[120:123], v[32:47]
    ds_read_b128 a[116:119], v88 offset:54272
    v_rcp_f32 v71, v71
    v_mul_f32 v64, v64, v24
    v_mul_f32 v65, v65, v25
    v_mul_f32 v66, v66, v26
    v_mul_f32 v67, v67, v27
    v_mul_f32 v68, v68, v28
    v_mul_f32 v69, v69, v29
    v_mul_f32 v70, v70, v30
    v_mul_f32 v71, v71, v31
    s_waitcnt lgkmcnt(4)
    v_mfma_f32_32x32x16_bf16 v[32:47], a[76:79], a[124:127], v[32:47]
    ds_read_b128 a[120:123], v88 offset:55296
    v_cvt_pk_bf16_f32 v76, v64, v65
    v_cvt_pk_bf16_f32 v77, v66, v67
    v_cvt_pk_bf16_f32 v78, v68, v69
    v_cvt_pk_bf16_f32 v79, v70, v71
    buffer_store_dwordx4 v[76:79], v12, s[56:59], s86 offen offset:512 sc1
    v_mfma_f32_32x32x16_bf16 v[32:47], a[80:83], v[48:51], v[32:47]
    ds_read_b128 a[124:127], v88 offset:56320
    v_mfma_f32_32x32x16_bf16 v[32:47], a[84:87], v[52:55], v[32:47]
    s_waitcnt lgkmcnt(3)
    v_mfma_f32_32x32x16_bf16 v[32:47], a[88:91], v[56:59], v[32:47]
    v_mfma_f32_32x32x16_bf16 v[32:47], a[92:95], v[60:63], v[32:47]
    v_mfma_f32_32x32x16_bf16 v[32:47], a[96:99], a[112:115], v[32:47]
    s_waitcnt lgkmcnt(0)
    v_mfma_f32_32x32x16_bf16 v[32:47], a[100:103], a[116:119], v[32:47]
    v_mfma_f32_32x32x16_bf16 v[32:47], a[104:107], a[120:123], v[32:47]
    v_mfma_f32_32x32x16_bf16 v[32:47], a[108:111], a[124:127], v[32:47]
    v_mfma_f32_32x32x16_bf16 v[32:47], v[6:9], v[2:5], v[32:47]
    s_nop 11
    v_mul_f32 v64, v32, v32
    v_mul_f32 v65, v33, v33
    v_mul_f32 v66, v34, v34
    v_mul_f32 v67, v35, v35
    v_mul_f32 v68, v36, v36
    v_mul_f32 v69, v37, v37
    v_mul_f32 v70, v38, v38
    v_mul_f32 v71, v39, v39
    v_fma_f32 v64, v64, v91, v90
    v_fma_f32 v65, v65, v91, v90
    v_fma_f32 v66, v66, v91, v90
    v_fma_f32 v67, v67, v91, v90
    v_fma_f32 v68, v68, v91, v90
    v_fma_f32 v69, v69, v91, v90
    v_fma_f32 v70, v70, v91, v90
    v_fma_f32 v71, v71, v91, v90
    v_mul_f32 v64, v64, v32
    v_mul_f32 v65, v65, v33
    v_mul_f32 v66, v66, v34
    v_mul_f32 v67, v67, v35
    v_mul_f32 v68, v68, v36
    v_mul_f32 v69, v69, v37
    v_mul_f32 v70, v70, v38
    v_mul_f32 v71, v71, v39
    v_exp_f32 v64, v64
    v_exp_f32 v65, v65
    v_exp_f32 v66, v66
    v_exp_f32 v67, v67
    v_exp_f32 v68, v68
    v_exp_f32 v69, v69
    v_exp_f32 v70, v70
    v_exp_f32 v71, v71
    v_fma_f32 v64, v64, v116, v116
    v_fma_f32 v65, v65, v116, v116
    v_fma_f32 v66, v66, v116, v116
    v_fma_f32 v67, v67, v116, v116
    v_fma_f32 v68, v68, v116, v116
    v_fma_f32 v69, v69, v116, v116
    v_fma_f32 v70, v70, v116, v116
    v_fma_f32 v71, v71, v116, v116
    v_rcp_f32 v64, v64
    v_rcp_f32 v65, v65
    v_rcp_f32 v66, v66
    v_rcp_f32 v67, v67
    v_rcp_f32 v68, v68
    v_rcp_f32 v69, v69
    v_rcp_f32 v70, v70
    v_rcp_f32 v71, v71
    v_mul_f32 v64, v64, v32
    v_mul_f32 v65, v65, v33
    v_mul_f32 v66, v66, v34
    v_mul_f32 v67, v67, v35
    v_mul_f32 v68, v68, v36
    v_mul_f32 v69, v69, v37
    v_mul_f32 v70, v70, v38
    v_mul_f32 v71, v71, v39
    v_cvt_pk_bf16_f32 v80, v64, v65
    v_cvt_pk_bf16_f32 v81, v66, v67
    v_cvt_pk_bf16_f32 v82, v68, v69
    v_cvt_pk_bf16_f32 v83, v70, v71
    buffer_store_dwordx4 v[80:83], v12, s[56:59], s87 offen offset:0 sc1
    v_mul_f32 v64, v40, v40
    v_mul_f32 v65, v41, v41
    v_mul_f32 v66, v42, v42
    v_mul_f32 v67, v43, v43
    v_mul_f32 v68, v44, v44
    v_mul_f32 v69, v45, v45
    v_mul_f32 v70, v46, v46
    v_mul_f32 v71, v47, v47
    v_fma_f32 v64, v64, v91, v90
    v_fma_f32 v65, v65, v91, v90
    v_fma_f32 v66, v66, v91, v90
    v_fma_f32 v67, v67, v91, v90
    v_fma_f32 v68, v68, v91, v90
    v_fma_f32 v69, v69, v91, v90
    v_fma_f32 v70, v70, v91, v90
    s_waitcnt vmcnt(1)
    s_cmp_eq_u32 s69, 0
    s_cbranch_scc1 Lfs4
    buffer_store_dword v15, v11, s[56:59], 0 offen offset:2048
Lfd4:
    v_fma_f32 v71, v71, v91, v90
    v_mul_f32 v64, v64, v40
    v_mul_f32 v65, v65, v41
    v_mul_f32 v66, v66, v42
    v_mul_f32 v67, v67, v43
    v_mul_f32 v68, v68, v44
    v_mul_f32 v69, v69, v45
    v_mul_f32 v70, v70, v46
    v_mul_f32 v71, v71, v47
    v_exp_f32 v64, v64
    v_exp_f32 v65, v65
    v_exp_f32 v66, v66
    v_exp_f32 v67, v67
    v_exp_f32 v68, v68
    v_exp_f32 v69, v69
    v_exp_f32 v70, v70
    v_exp_f32 v71, v71
    v_fma_f32 v64, v64, v116, v116
    v_fma_f32 v65, v65, v116, v116
    v_fma_f32 v66, v66, v116, v116
    v_fma_f32 v67, v67, v116, v116
    v_fma_f32 v68, v68, v116, v116
    v_fma_f32 v69, v69, v116, v116
    v_fma_f32 v70, v70, v116, v116
    v_fma_f32 v71, v71, v116, v116
    v_rcp_f32 v64, v64
    v_rcp_f32 v65, v65
    v_rcp_f32 v66, v66
    v_rcp_f32 v67, v67
    v_rcp_f32 v68, v68
    v_rcp_f32 v69, v69
    v_rcp_f32 v70, v70
    v_rcp_f32 v71, v71
    v_mul_f32 v64, v64, v40
    v_mul_f32 v65, v65, v41
    v_mul_f32 v66, v66, v42
    v_mul_f32 v67, v67, v43
    v_mul_f32 v68, v68, v44
    v_mul_f32 v69, v69, v45
    v_mul_f32 v70, v70, v46
    v_mul_f32 v71, v71, v47
    v_cvt_pk_bf16_f32 v84, v64, v65
    v_cvt_pk_bf16_f32 v85, v66, v67
    v_cvt_pk_bf16_f32 v86, v68, v69
    v_cvt_pk_bf16_f32 v87, v70, v71
    buffer_store_dwordx4 v[84:87], v12, s[56:59], s87 offen offset:512 sc1
    v_lshlrev_b32 v32, 16, v104
    v_and_b32 v33, 0xffff0000, v104
    v_lshlrev_b32 v34, 16, v105
    v_and_b32 v35, 0xffff0000, v105
    v_pk_add_f32 v[32:33], v[32:33], v[112:113]
    v_pk_add_f32 v[34:35], v[34:35], v[114:115]
    v_lshlrev_b32 v36, 16, v106
    v_and_b32 v37, 0xffff0000, v106
    v_lshlrev_b32 v38, 16, v107
    v_and_b32 v39, 0xffff0000, v107
    v_pk_add_f32 v[36:37], v[36:37], v[112:113]
    v_pk_add_f32 v[38:39], v[38:39], v[114:115]
    s_mov_b32 s85, 14336
    v_lshlrev_b32 v40, 16, v108
    v_and_b32 v41, 0xffff0000, v108
    v_lshlrev_b32 v42, 16, v109
    v_and_b32 v43, 0xffff0000, v109
    v_pk_add_f32 v[40:41], v[40:41], v[112:113]
    v_pk_add_f32 v[42:43], v[42:43], v[114:115]
    s_mov_b32 s86, 28672
    v_lshlrev_b32 v44, 16, v110
    v_and_b32 v45, 0xffff0000, v110
    v_lshlrev_b32 v46, 16, v111
    v_and_b32 v47, 0xffff0000, v111
    v_pk_add_f32 v[44:45], v[44:45], v[112:113]
    v_pk_add_f32 v[46:47], v[46:47], v[114:115]
    s_mov_b32 s87, 43008
    s_waitcnt vmcnt(0)
    s_cmp_eq_u32 s69, 0
    s_cbranch_scc1 Lfs5
    buffer_store_dword v15, v11, s[56:59], 0 offen offset:3072
Lfd5:
    s_setprio 0
    s_or_b32 s4, s70, s60
    s_cbranch_scc1 Lep
    s_mov_b32 s4, 724736
    s_mov_b64 exec, 1
    buffer_store_dword v15, v0, s[56:59], s4 offen
    s_mov_b64 exec, -1
Lep:
    s_barrier
    ds_read_b128 v[16:19], v125 offset:0
    ds_read_b128 v[20:23], v125 offset:4352
    ds_read_b128 v[24:27], v125 offset:8704
    ds_read_b128 v[28:31], v125 offset:13056
    s_waitcnt lgkmcnt(3)
    v_add_f32 v32, v32, v16
    v_add_f32 v33, v33, v17
    v_add_f32 v34, v34, v18
    v_add_f32 v35, v35, v19
    s_waitcnt lgkmcnt(2)
    v_add_f32 v32, v32, v20
    v_add_f32 v33, v33, v21
    v_add_f32 v34, v34, v22
    v_add_f32 v35, v35, v23
    s_waitcnt lgkmcnt(1)
    v_add_f32 v32, v32, v24
    v_add_f32 v33, v33, v25
    v_add_f32 v34, v34, v26
    v_add_f32 v35, v35, v27
    s_waitcnt lgkmcnt(0)
    v_add_f32 v32, v32, v28
    v_add_f32 v33, v33, v29
    v_add_f32 v34, v34, v30
    v_add_f32 v35, v35, v31
    v_cvt_pk_bf16_f32 v32, v32, v33
    v_cvt_pk_bf16_f32 v33, v34, v35
    buffer_store_dwordx2 v[32:33], v119, s[52:55], 0 offen
    ds_read_b128 v[16:19], v125 offset:17408
    ds_read_b128 v[20:23], v125 offset:21760
    ds_read_b128 v[24:27], v125 offset:26112
    ds_read_b128 v[28:31], v125 offset:30464
    s_waitcnt lgkmcnt(3)
    v_add_f32 v36, v36, v16
    v_add_f32 v37, v37, v17
    v_add_f32 v38, v38, v18
    v_add_f32 v39, v39, v19
    s_waitcnt lgkmcnt(2)
    v_add_f32 v36, v36, v20
    v_add_f32 v37, v37, v21
    v_add_f32 v38, v38, v22
    v_add_f32 v39, v39, v23
    s_waitcnt lgkmcnt(1)
    v_add_f32 v36, v36, v24
    v_add_f32 v37, v37, v25
    v_add_f32 v38, v38, v26
    v_add_f32 v39, v39, v27
    s_waitcnt lgkmcnt(0)
    v_add_f32 v36, v36, v28
    v_add_f32 v37, v37, v29
    v_add_f32 v38, v38, v30
    v_add_f32 v39, v39, v31
    v_cvt_pk_bf16_f32 v36, v36, v37
    v_cvt_pk_bf16_f32 v37, v38, v39
    buffer_store_dwordx2 v[36:37], v119, s[52:55], s85 offen
    s_barrier
    ds_read_b128 v[16:19], v125 offset:51200
    ds_read_b128 v[20:23], v125 offset:55552
    ds_read_b128 v[24:27], v125 offset:59904
    ds_read_b128 v[28:31], v125 offset:64256
    s_waitcnt lgkmcnt(3)
    v_add_f32 v40, v40, v16
    v_add_f32 v41, v41, v17
    v_add_f32 v42, v42, v18
    v_add_f32 v43, v43, v19
    s_waitcnt lgkmcnt(2)
    v_add_f32 v40, v40, v20
    v_add_f32 v41, v41, v21
    v_add_f32 v42, v42, v22
    v_add_f32 v43, v43, v23
    s_waitcnt lgkmcnt(1)
    v_add_f32 v40, v40, v24
    v_add_f32 v41, v41, v25
    v_add_f32 v42, v42, v26
    v_add_f32 v43, v43, v27
    s_waitcnt lgkmcnt(0)
    v_add_f32 v40, v40, v28
    v_add_f32 v41, v41, v29
    v_add_f32 v42, v42, v30
    v_add_f32 v43, v43, v31
    v_cvt_pk_bf16_f32 v40, v40, v41
    v_cvt_pk_bf16_f32 v41, v42, v43
    buffer_store_dwordx2 v[40:41], v119, s[52:55], s86 offen
    s_barrier
    ds_read_b128 v[16:19], v125 offset:0
    ds_read_b128 v[20:23], v125 offset:4352
    ds_read_b128 v[24:27], v125 offset:8704
    ds_read_b128 v[28:31], v125 offset:13056
    s_waitcnt lgkmcnt(3)
    v_pk_add_f32 v[44:45], v[44:45], v[16:17]
    v_pk_add_f32 v[46:47], v[46:47], v[18:19]
    s_waitcnt lgkmcnt(2)
    v_pk_add_f32 v[44:45], v[44:45], v[20:21]
    v_pk_add_f32 v[46:47], v[46:47], v[22:23]
    s_waitcnt lgkmcnt(1)
    v_pk_add_f32 v[44:45], v[44:45], v[24:25]
    v_pk_add_f32 v[46:47], v[46:47], v[26:27]
    s_waitcnt lgkmcnt(0)
    v_pk_add_f32 v[44:45], v[44:45], v[28:29]
    v_pk_add_f32 v[46:47], v[46:47], v[30:31]
    v_cvt_pk_bf16_f32 v44, v44, v45
    v_cvt_pk_bf16_f32 v45, v46, v47
    buffer_store_dwordx2 v[44:45], v119, s[52:55], s87 offen
Lfin0:
Lfin:
    s_endpgm
Lidf:
    s_add_u32 s81, s81, 1
    s_cmp_gt_u32 s81, 0x800000
    s_cbranch_scc1 Lidk
    buffer_load_dword v1, v125, s[56:59], s43 offen sc1
    s_waitcnt vmcnt(0)
    s_branch Lid
Lfs0:
    buffer_store_dword v15, v11, s[56:59], 0 offen sc1
    s_branch Lfd0
Lpvq:
    s_sub_u32 s74, s74, 1024
    v_lshlrev_b32 v5, 2, v0
    s_mov_b64 exec, 63
    s_mov_b32 s81, 0
Lpwq:
    buffer_load_dword v1, v5, s[56:59], s74 offen sc1
    s_add_u32 s81, s81, 1
    s_waitcnt vmcnt(0)
    v_cmp_ne_u32 vcc, v1, v15
    s_cmp_gt_u32 s81, 0x800000
    s_cbranch_scc1 Lpxq
    s_cbranch_vccnz Lpwq
Lpxq:
    s_mov_b64 exec, -1
    s_branch Lpkq
Lds0:
    buffer_store_dwordx4 v[80:83], v14, s[56:59], s79 offen sc1
    s_branch Ldd0
Lds1:
    buffer_store_dwordx4 v[84:87], v14, s[56:59], s80 offen sc1
    s_branch Ldd1
Lfs1:
    buffer_store_dword v15, v11, s[56:59], 0 offen sc1
    s_branch Lfd1
Lpvh:
    s_sub_u32 s74, s74, 512
    v_lshlrev_b32 v5, 2, v0
    s_mov_b64 exec, 16383
    s_mov_b32 s81, 0
Lpwh:
    buffer_load_dword v1, v5, s[56:59], s74 offen sc1
    s_add_u32 s81, s81, 1
    s_waitcnt vmcnt(0)
    v_cmp_ne_u32 vcc, v1, v15
    s_cmp_gt_u32 s81, 0x800000
    s_cbranch_scc1 Lpxh
    s_cbranch_vccnz Lpwh
Lpxh:
    s_mov_b64 exec, -1
    s_branch Lpkh
Lfs2:
    buffer_store_dword v15, v11, s[56:59], 0 offen sc1
    s_branch Lfd2
Lfs3:
    buffer_store_dword v15, v11, s[56:59], 0 offen offset:1024 sc1
    s_branch Lfd3
Lfs4:
    buffer_store_dword v15, v11, s[56:59], 0 offen offset:2048 sc1
    s_branch Lfd4
Lfs5:
    buffer_store_dword v15, v11, s[56:59], 0 offen offset:3072 sc1
    s_branch Lfd5
Lcv0:
    s_sub_u32 s74, s74, 1024
    s_mov_b32 s81, 0
    s_mov_b64 exec, 0xfffffff
    v_lshlrev_b32 v40, 2, v0
Lcw0:
    buffer_load_dword v41, v40, s[56:59], s74 offen sc1
    s_add_u32 s81, s81, 1
    s_waitcnt vmcnt(0)
    v_cmp_ne_u32 vcc, s26, v41
    s_cmp_gt_u32 s81, 0x800000
    s_cbranch_scc1 Lcx0
    s_cbranch_vccnz Lcw0
Lcx0:
    s_mov_b64 exec, -1
    s_branch Lck0
Lgvh:
    s_sub_u32 s74, s74, 512
    s_mov_b32 s81, 0
    s_mov_b64 exec, 16383
    v_mbcnt_lo_u32_b32 v40, -1, 0
    v_lshlrev_b32 v40, 2, v40
Lgwh:
    buffer_load_dword v41, v40, s[56:59], s74 offen sc1
    s_add_u32 s81, s81, 1
    s_waitcnt vmcnt(0)
    v_cmp_ne_u32 vcc, s26, v41
    s_cmp_gt_u32 s81, 0x800000
    s_cbranch_scc1 Lgxh
    s_cbranch_vccnz Lgwh
Lgxh:
    s_mov_b64 exec, -1
    s_branch Lgkh
Lgv0:
    s_sub_u32 s74, s74, 256
    s_mov_b32 s81, 0
    s_mov_b64 exec, 16383
    v_mbcnt_lo_u32_b32 v6, -1, 0
    v_lshlrev_b32 v6, 2, v6
Lgw0:
    buffer_load_dword v7, v6, s[56:59], s74 offen sc1
    s_add_u32 s81, s81, 1
    s_waitcnt vmcnt(0)
    v_cmp_ne_u32 vcc, s26, v7
    s_cmp_gt_u32 s81, 0x800000
    s_cbranch_scc1 Lgx0
    s_cbranch_vccnz Lgw0
Lgx0:
    s_mov_b64 exec, -1
    s_branch Lgk0
Lgv1:
    s_sub_u32 s74, s74, 256
    s_mov_b32 s81, 0
    s_mov_b64 exec, 16383
    v_mbcnt_lo_u32_b32 v22, -1, 0
    v_lshlrev_b32 v22, 2, v22
Lgw1:
    buffer_load_dword v23, v22, s[56:59], s74 offen sc1
    s_add_u32 s81, s81, 1
    s_waitcnt vmcnt(0)
    v_cmp_ne_u32 vcc, s26, v23
    s_cmp_gt_u32 s81, 0x800000
    s_cbranch_scc1 Lgx1
    s_cbranch_vccnz Lgw1
Lgx1:
    s_mov_b64 exec, -1
    s_branch Lgk1
Lgv2:
    s_sub_u32 s74, s74, 256
    s_mov_b32 s81, 0
    s_mov_b64 exec, 16383
    v_mbcnt_lo_u32_b32 v38, -1, 0
    v_lshlrev_b32 v38, 2, v38
Lgw2:
    buffer_load_dword v39, v38, s[56:59], s74 offen sc1
    s_add_u32 s81, s81, 1
    s_waitcnt vmcnt(0)
    v_cmp_ne_u32 vcc, s26, v39
    s_cmp_gt_u32 s81, 0x800000
    s_cbranch_scc1 Lgx2
    s_cbranch_vccnz Lgw2
Lgx2:
    s_mov_b64 exec, -1
    s_branch Lgk2
Lgv3:
    s_sub_u32 s74, s74, 256
    s_mov_b32 s81, 0
    s_mov_b64 exec, 16383
    v_mbcnt_lo_u32_b32 v14, -1, 0
    v_lshlrev_b32 v14, 2, v14
Lgw3:
    buffer_load_dword v15, v14, s[56:59], s74 offen sc1
    s_add_u32 s81, s81, 1
    s_waitcnt vmcnt(0)
    v_cmp_ne_u32 vcc, s26, v15
    s_cmp_gt_u32 s81, 0x800000
    s_cbranch_scc1 Lgx3
    s_cbranch_vccnz Lgw3
Lgx3:
    s_mov_b64 exec, -1
    s_branch Lgk3
Lend:
    s_endpgm
.section .rodata,"a"
.p2align 6
.amdhsa_kernel sequential_preLN__sliding_local_dilated__dense_activation_gelu__prompt_kernel
  .amdhsa_next_free_vgpr 256
  .amdhsa_next_free_sgpr 102
  .amdhsa_accum_offset 128
  .amdhsa_group_segment_fixed_size 0
  .amdhsa_kernarg_size 88
  .amdhsa_user_sgpr_count 2
  .amdhsa_user_sgpr_kernarg_segment_ptr 1
  .amdhsa_system_sgpr_workgroup_id_x 1
.end_amdhsa_kernel
```
